```python
import torch

def _softmax(x, axis=-1):
    return torch.softmax(x, dim=axis)
def _gelu(x):
    return torch.nn.functional.gelu(x, approximate="tanh")
def _silu(x):
    return torch.nn.functional.silu(x)
def _sigmoid(x):
    return torch.sigmoid(x)
def _layernorm(x, axis=-1, eps=1e-5):
    m = x.mean(dim=axis, keepdim=True)
    v = x.var(dim=axis, keepdim=True, unbiased=False)
    return (x - m) / torch.sqrt(v + eps)
def _scatter_add(tgt, idx, src, axis=0):
    return tgt.clone().index_add_(axis, idx, src)
def _segment_sum(src, seg, n):
    out = torch.zeros((n,) + src.shape[1:], dtype=src.dtype)
    return out.index_add_(0, seg, src)
def _pad(x, pw):
    flat = tuple(v for pair in reversed(pw) for v in pair)
    return torch.nn.functional.pad(x, flat)

kernel_name = 'parallel_sum__mha_block__dense_activation_gelu__prompt'

def setup_inputs():

    _w = (lambda a: (lambda t: t.to(torch.bfloat16) if t.is_floating_point() else t)(torch.as_tensor(a)))
    def _A_setup():
        B, S, D, H = 1, 2048, 448, 16
        return {
            "x": _w((lambda *s: torch.randn(*s, dtype=torch.bfloat16) * 0.05)(B, S, D)),
            "wqkv": _w((lambda *s: torch.randn(*s, dtype=torch.bfloat16) * 0.05)(D, 3 * D)),
            "wo": _w((lambda *s: torch.randn(*s, dtype=torch.bfloat16) * 0.05)(D, D)),
        }
    _A_in = _A_setup()

    def _B_setup():
        B, S, D, F = 1, 2048, 448, 1792
        return {
            "x": _w((lambda *s: torch.randn(*s, dtype=torch.bfloat16) * 0.05)(B, S, D)),
            "w1": _w((lambda *s: torch.randn(*s, dtype=torch.bfloat16) * 0.8)(D, F) * (D ** -0.5)),
            "b1": _w((lambda *s: torch.randn(*s, dtype=torch.bfloat16) * 12.8)(F) * 0.01),
            "w2": _w((lambda *s: torch.randn(*s, dtype=torch.bfloat16) * 0.4)(F, D) * (F ** -0.5)),
            "b2": _w((lambda *s: torch.randn(*s, dtype=torch.bfloat16) * 6.4)(D) * 0.01),
        }
    _B_in = _B_setup()

    return {
        "A_x": _A_in["x"],
        "A_wqkv": _A_in["wqkv"],
        "A_wo": _A_in["wo"],
        "B_x": _B_in["x"],
        "B_w1": _B_in["w1"],
        "B_b1": _B_in["b1"],
        "B_w2": _B_in["w2"],
        "B_b2": _B_in["b2"],
    }

def reference(A_x, A_wqkv, A_wo, B_x, B_w1, B_b1, B_w2, B_b2):
    def _A_ref(x, wqkv, wo):
        B, S, D = x.shape
        H = 16
        Dh = D // H
        qkv = (lambda x, *d: x.permute(*d))((x @ wqkv).reshape(B, S, 3, H, Dh), 2, 0, 3, 1, 4)
        q, k, v = qkv[0], qkv[1], qkv[2]
        scores = torch.einsum("bhqd,bhkd->bhqk", q, k) * (Dh ** -0.5)
        p = _softmax(scores, axis=-1)
        o = torch.einsum("bhqk,bhkd->bhqd", p, v)
        return (lambda x, *d: x.permute(*d))(o, 0, 2, 1, 3).reshape(B, S, D) @ wo

    def _B_ref(x, w1, b1, w2, b2):
        h = torch.einsum("bsd,df->bsf", x, w1) + b1
        h = _gelu(h)
        return torch.einsum("bsf,fd->bsd", h, w2) + b2

    x = A_x
    xn = _layernorm(x, axis=-1)
    return x + _A_ref(xn, A_wqkv, A_wo) + _B_ref(xn, B_w1, B_b1, B_w2, B_b2)
```

```asm
; @launch kernel=fused_kernel grid=(256,1,1) block=(512,1,1) lds=157952
.amdgcn_target "amdgcn-amd-amdhsa--gfx950"
.text
.p2align 8
CODE_START:
.globl fused_kernel
.p2align 8
.type fused_kernel,@function
fused_kernel:
    s_cmp_ge_u32 s2, 256
    s_cbranch_scc1 MG_EXIT
    s_load_dwordx2 s[4:5], s[0:1], 80
    s_load_dwordx2 s[52:53], s[0:1], 0
    s_load_dwordx2 s[54:55], s[0:1], 8
    s_load_dwordx2 s[58:59], s[0:1], 32
    s_load_dwordx2 s[60:61], s[0:1], 40
    s_load_dwordx2 s[56:57], s[0:1], 48
    s_load_dwordx2 s[86:87], s[0:1], 16
    s_load_dwordx2 s[96:97], s[0:1], 72
    v_and_b32 v1, 63, v0
    v_lshrrev_b32 v3, 6, v0
    v_lshlrev_b32 v2, 4, v1
    v_readfirstlane_b32 s12, v3
    s_lshr_b32 s15, s2, 3
    s_cmp_ge_u32 s15, 2
    s_cbranch_scc1 CT_SKIP
    s_cmp_lt_u32 s12, 4
    s_cbranch_scc1 CT_SKIP
    s_getpc_b64 s[92:93]
CT_PC:
    s_sub_u32 s92, s92, CT_PC-CODE_START
    s_subb_u32 s93, s93, 0
    s_lshl_b32 s15, s15, 2
    s_add_u32 s15, s15, s12
    s_sub_u32 s15, s15, 4
    s_lshl_b32 s15, s15, 13
    v_lshlrev_b32 v3, 7, v1
    v_add_u32 v3, s15, v3
    v_min_u32 v3, CODE_END-CODE_START-4, v3
    global_load_dword v31, v3, s[92:93]
CT_SKIP:
    s_and_b32 s15, s2, 1
    s_lshl_b32 s15, s15, 3
    s_bfe_u32 s13, s2, 0x30003
    s_add_u32 s13, s13, s15
    s_bfe_u32 s15, s2, 0x20001
    s_lshl_b32 s15, s15, 2
    s_lshr_b32 s14, s2, 6
    s_add_u32 s14, s14, s15
    s_cmp_lt_u32 s13, 5
    s_cbranch_scc1 PRM_LO
    s_add_u32 s44, s13, 5
    s_cmp_ge_u32 s44, 14
    s_cselect_b32 s40, 1, 0
    s_lshl_b32 s17, s44, 2
    s_or_b32 s40, s40, s17
    s_lshl_b32 s44, s13, 1
    s_sub_u32 s44, s44, 5
    s_lshl_b32 s41, s44, 2
    s_or_b32 s41, s41, 2
    s_add_u32 s42, s41, 4
    s_cmp_ge_u32 s13, 14
    s_mov_b32 s43, 3
    s_cselect_b32 s43, 110, s43
    s_cselect_b32 s19, 7, 6
    s_mov_b32 s36, 1
    s_branch PRM_J
PRM_LO:
    s_lshl_b32 s44, s13, 1
    s_cmp_ge_u32 s44, 14
    s_cselect_b32 s40, 1, 0
    s_lshl_b32 s17, s44, 2
    s_or_b32 s40, s40, s17
    s_add_u32 s44, s44, 1
    s_cmp_ge_u32 s44, 14
    s_cselect_b32 s41, 1, 0
    s_lshl_b32 s17, s44, 2
    s_or_b32 s41, s41, s17
    s_lshl_b32 s42, s13, 2
    s_or_b32 s42, s42, 2
    s_mov_b32 s43, 3
    s_mov_b32 s19, 6
    s_mov_b32 s36, 2
PRM_J:
    s_lshl_b32 s41, s41, 8
    s_lshl_b32 s42, s42, 16
    s_lshl_b32 s43, s43, 24
    s_or_b32 s18, s40, s41
    s_or_b32 s18, s18, s42
    s_or_b32 s18, s18, s43
    s_cmp_ge_u32 s12, 4
    s_cbranch_scc1 MG_LOADER
    s_lshl_b32 s25, s14, 2
    s_add_u32 s25, s25, s12
    s_mul_i32 s23, s25, 28672
    s_mul_i32 s90, s12, 24576
    s_add_u32 s90, s90, 57344
    v_and_b32 v3, 31, v1
    v_lshlrev_b32 v25, 4, v3
    v_lshrrev_b32 v24, 5, v1
    v_mul_u32_u24 v13, 896, v3
    v_lshlrev_b32 v4, 4, v24
    v_add_u32 v13, v13, v4
    v_lshrrev_b32 v9, 5, v0
    v_lshrrev_b32 v10, 1, v9
    v_lshlrev_b32 v10, 3, v10
    v_mov_b32 v11, s18
    v_lshrrev_b32 v10, v10, v11
    v_and_b32 v11, 1, v9
    s_and_b32 s15, s13, 1
    v_mov_b32 v12, s15
    v_cmp_eq_u32 vcc, 6, v9
    s_nop 1
    v_cndmask_b32 v11, v11, v12, vcc
    v_bfe_u32 v12, v10, 2, 6
    v_lshlrev_b32 v12, 1, v12
    v_add_u32 v12, v12, v11
    v_lshlrev_b32 v12, 5, v12
    v_and_b32 v11, 31, v0
    v_add_u32 v12, v12, v11
    v_lshlrev_b32 v12, 1, v12
    v_and_b32 v10, 3, v10
    v_cmp_eq_u32 vcc, 2, v10
    v_mov_b32 v11, 0x10000000
    s_nop 0
    v_cndmask_b32 v12, v11, v12, vcc
    s_waitcnt lgkmcnt(0)
    s_mov_b32 s40, s52
    s_and_b32 s41, s53, 0xffff
    s_mov_b32 s42, 1835008
    s_mov_b32 s43, 0x00020000
    s_mov_b32 s48, s60
    s_and_b32 s49, s61, 0xffff
    s_mov_b32 s50, 3584
    s_mov_b32 s51, 0x00020000
    s_mov_b32 s8, s4
    s_and_b32 s9, s5, 0xffff
    s_mov_b32 s10, 20971520
    s_mov_b32 s11, 0x00020000
    v_min_u32 v4, 27, v1
    v_mul_u32_u24 v5, 37, v4
    v_lshrrev_b32 v5, 8, v5
    v_mul_u32_u24 v14, 7, v5
    v_sub_u32 v4, v4, v14
    v_lshlrev_b32 v4, 7, v4
    v_mul_u32_u24 v5, 896, v5
    v_add_u32 v4, v4, v5
    s_bfe_u32 s91, s2, 0x30003
    s_lshl_b32 s91, s91, 4
    s_lshl_b32 s92, s12, 2
    s_add_u32 s91, s91, s92
    s_lshl_b32 s92, s14, 7
    s_add_u32 s91, s91, s92
    s_mul_i32 s91, s91, 896
    buffer_load_dword v14, v4, s[40:43], s91 offen
    buffer_load_dwordx4 v[128:131], v13, s[40:43], s23 offen offset:768
    buffer_load_dwordx4 v[132:135], v13, s[40:43], s23 offen offset:800
    buffer_load_dwordx4 v[136:139], v13, s[40:43], s23 offen offset:832
    buffer_load_dwordx4 v[140:143], v13, s[40:43], s23 offen offset:864
    buffer_load_ushort v27, v12, s[48:51], 0 offen
    v_bfe_u32 v4, v3, 1, 3
    v_xor_b32 v4, v4, v24
    v_lshlrev_b32 v4, 4, v4
    v_lshlrev_b32 v15, 7, v3
    v_add_u32 v15, v15, v4
    v_add_u32 v15, s90, v15
    v_xor_b32 v16, 32, v15
    v_xor_b32 v17, 64, v15
    v_xor_b32 v18, 96, v15
    v_lshlrev_b32 v3, 3, v24
    v_bfe_u32 v4, v1, 2, 2
    v_add_u32 v3, v3, v4
    v_lshlrev_b32 v7, 7, v3
    v_lshrrev_b32 v4, 1, v4
    v_lshlrev_b32 v4, 6, v4
    v_add_u32 v7, v7, v4
    v_bfe_u32 v3, v1, 4, 1
    v_lshlrev_b32 v3, 5, v3
    v_add_u32 v7, v7, v3
    v_and_b32 v3, 3, v1
    v_lshlrev_b32 v3, 3, v3
    v_add_u32 v7, v7, v3
    v_mov_b32 v28, 0x3f803f80
    v_lshlrev_b32 v29, 4, v24
    v_add_u32 v29, 155648, v29
    s_lshl_b32 s15, s12, 12
    s_add_u32 s15, s15, 114688
    v_add_u32 v6, s15, v2
    v_mov_b32 v228, 0
    v_mov_b32 v229, 0
    v_mov_b32 v230, 0
    v_mov_b32 v231, 0
    s_and_b32 s86, s2, 7
    s_lshr_b32 s87, s2, 3
    s_lshl_b32 s84, s86, 1
    s_and_b32 s86, s87, 1
    s_add_u32 s84, s84, s86
    s_lshr_b32 s85, s87, 1
    s_mul_i32 s86, s84, 28
    s_lshr_b32 s88, s86, 6
    s_add_u32 s86, s86, 27
    s_lshr_b32 s89, s86, 6
    v_min_u32 v238, 18, v1
    v_cmp_eq_u32 vcc, 18, v238
    s_nop 1
    v_cndmask_b32 v238, v238, 0, vcc
    v_and_b32 v236, 1, v238
    v_mov_b32 v237, s88
    v_mov_b32 v239, s89
    v_cmp_eq_u32 vcc, 1, v236
    s_nop 1
    v_cndmask_b32 v236, v237, v239, vcc
    v_cmp_le_u32 vcc, 2, v238
    s_nop 1
    v_cndmask_b32 v237, 0, 1, vcc
    v_cmp_le_u32 vcc, 10, v238
    s_nop 1
    v_cndmask_b32 v239, 0, 1, vcc
    v_add_u32 v237, v237, v239
    v_mul_u32_u24 v240, 7, v237
    v_add_u32 v236, v236, v240
    v_lshlrev_b32 v239, 3, v239
    v_add_u32 v239, 2, v239
    v_sub_u32 v239, v238, v239
    v_lshrrev_b32 v239, 1, v239
    v_and_b32 v239, 3, v239
    s_lshl_b32 s86, s12, 2
    v_add_u32 v239, s86, v239
    v_mov_b32 v240, s85
    v_cmp_gt_u32 vcc, 2, v238
    s_nop 1
    v_cndmask_b32 v239, v239, v240, vcc
    v_lshrrev_b32 v237, 1, v236
    v_subrev_u32 v240, 5, v236
    v_cmp_gt_u32 vcc, 10, v236
    s_nop 1
    v_cndmask_b32 v236, v240, v237, vcc
    v_lshlrev_b32 v236, 4, v236
    v_add_u32 v236, v236, v239
    v_lshlrev_b32 v26, 7, v236
    s_barrier
    ds_read_b128 v[32:35], v15 offset:0
    ds_read_b128 v[36:39], v16 offset:0
    ds_read_b128 v[40:43], v17 offset:0
    ds_read_b128 v[44:47], v18 offset:0
    s_waitcnt vmcnt(1)
    v_dot2_f32_bf16 v228, v128, v28, v228
    v_dot2_f32_bf16 v230, v128, v128, v230
    v_dot2_f32_bf16 v229, v129, v28, v229
    v_dot2_f32_bf16 v231, v129, v129, v231
    v_dot2_f32_bf16 v228, v130, v28, v228
    v_dot2_f32_bf16 v230, v130, v130, v230
    v_dot2_f32_bf16 v229, v131, v28, v229
    v_dot2_f32_bf16 v231, v131, v131, v231
    v_dot2_f32_bf16 v228, v132, v28, v228
    v_dot2_f32_bf16 v230, v132, v132, v230
    v_dot2_f32_bf16 v229, v133, v28, v229
    v_dot2_f32_bf16 v231, v133, v133, v231
    v_dot2_f32_bf16 v228, v134, v28, v228
    v_dot2_f32_bf16 v230, v134, v134, v230
    v_dot2_f32_bf16 v229, v135, v28, v229
    v_dot2_f32_bf16 v231, v135, v135, v231
    v_dot2_f32_bf16 v228, v136, v28, v228
    v_dot2_f32_bf16 v230, v136, v136, v230
    v_dot2_f32_bf16 v229, v137, v28, v229
    v_dot2_f32_bf16 v231, v137, v137, v231
    v_dot2_f32_bf16 v228, v138, v28, v228
    v_dot2_f32_bf16 v230, v138, v138, v230
    v_dot2_f32_bf16 v229, v139, v28, v229
    v_dot2_f32_bf16 v231, v139, v139, v231
    v_dot2_f32_bf16 v228, v140, v28, v228
    v_dot2_f32_bf16 v230, v140, v140, v230
    v_dot2_f32_bf16 v229, v141, v28, v229
    v_dot2_f32_bf16 v231, v141, v141, v231
    v_dot2_f32_bf16 v228, v142, v28, v228
    v_dot2_f32_bf16 v230, v142, v142, v230
    v_dot2_f32_bf16 v229, v143, v28, v229
    v_dot2_f32_bf16 v231, v143, v143, v231
    s_barrier
    ds_read_b128 v[48:51], v15 offset:4096
    ds_read_b128 v[52:55], v16 offset:4096
    ds_read_b128 v[56:59], v17 offset:4096
    ds_read_b128 v[60:63], v18 offset:4096
    s_waitcnt lgkmcnt(4)
    v_dot2_f32_bf16 v228, v32, v28, v228
    v_dot2_f32_bf16 v230, v32, v32, v230
    v_dot2_f32_bf16 v229, v33, v28, v229
    v_dot2_f32_bf16 v231, v33, v33, v231
    v_dot2_f32_bf16 v228, v34, v28, v228
    v_dot2_f32_bf16 v230, v34, v34, v230
    v_dot2_f32_bf16 v229, v35, v28, v229
    v_dot2_f32_bf16 v231, v35, v35, v231
    v_dot2_f32_bf16 v228, v36, v28, v228
    v_dot2_f32_bf16 v230, v36, v36, v230
    v_dot2_f32_bf16 v229, v37, v28, v229
    v_dot2_f32_bf16 v231, v37, v37, v231
    v_dot2_f32_bf16 v228, v38, v28, v228
    v_dot2_f32_bf16 v230, v38, v38, v230
    v_dot2_f32_bf16 v229, v39, v28, v229
    v_dot2_f32_bf16 v231, v39, v39, v231
    v_dot2_f32_bf16 v228, v40, v28, v228
    v_dot2_f32_bf16 v230, v40, v40, v230
    v_dot2_f32_bf16 v229, v41, v28, v229
    v_dot2_f32_bf16 v231, v41, v41, v231
    v_dot2_f32_bf16 v228, v42, v28, v228
    v_dot2_f32_bf16 v230, v42, v42, v230
    v_dot2_f32_bf16 v229, v43, v28, v229
    v_dot2_f32_bf16 v231, v43, v43, v231
    v_dot2_f32_bf16 v228, v44, v28, v228
    v_dot2_f32_bf16 v230, v44, v44, v230
    v_dot2_f32_bf16 v229, v45, v28, v229
    v_dot2_f32_bf16 v231, v45, v45, v231
    v_dot2_f32_bf16 v228, v46, v28, v228
    v_dot2_f32_bf16 v230, v46, v46, v230
    v_dot2_f32_bf16 v229, v47, v28, v229
    v_dot2_f32_bf16 v231, v47, v47, v231
    s_barrier
    ds_read_b128 v[64:67], v15 offset:8192
    ds_read_b128 v[68:71], v16 offset:8192
    ds_read_b128 v[72:75], v17 offset:8192
    ds_read_b128 v[76:79], v18 offset:8192
    s_waitcnt lgkmcnt(4)
    v_dot2_f32_bf16 v228, v48, v28, v228
    v_dot2_f32_bf16 v230, v48, v48, v230
    v_dot2_f32_bf16 v229, v49, v28, v229
    v_dot2_f32_bf16 v231, v49, v49, v231
    v_dot2_f32_bf16 v228, v50, v28, v228
    v_dot2_f32_bf16 v230, v50, v50, v230
    v_dot2_f32_bf16 v229, v51, v28, v229
    v_dot2_f32_bf16 v231, v51, v51, v231
    v_dot2_f32_bf16 v228, v52, v28, v228
    v_dot2_f32_bf16 v230, v52, v52, v230
    v_dot2_f32_bf16 v229, v53, v28, v229
    v_dot2_f32_bf16 v231, v53, v53, v231
    v_dot2_f32_bf16 v228, v54, v28, v228
    v_dot2_f32_bf16 v230, v54, v54, v230
    v_dot2_f32_bf16 v229, v55, v28, v229
    v_dot2_f32_bf16 v231, v55, v55, v231
    v_dot2_f32_bf16 v228, v56, v28, v228
    v_dot2_f32_bf16 v230, v56, v56, v230
    v_dot2_f32_bf16 v229, v57, v28, v229
    v_dot2_f32_bf16 v231, v57, v57, v231
    v_dot2_f32_bf16 v228, v58, v28, v228
    v_dot2_f32_bf16 v230, v58, v58, v230
    v_dot2_f32_bf16 v229, v59, v28, v229
    v_dot2_f32_bf16 v231, v59, v59, v231
    v_dot2_f32_bf16 v228, v60, v28, v228
    v_dot2_f32_bf16 v230, v60, v60, v230
    v_dot2_f32_bf16 v229, v61, v28, v229
    v_dot2_f32_bf16 v231, v61, v61, v231
    v_dot2_f32_bf16 v228, v62, v28, v228
    v_dot2_f32_bf16 v230, v62, v62, v230
    v_dot2_f32_bf16 v229, v63, v28, v229
    v_dot2_f32_bf16 v231, v63, v63, v231
    s_barrier
    ds_read_b128 v[80:83], v15 offset:12288
    ds_read_b128 v[84:87], v16 offset:12288
    ds_read_b128 v[88:91], v17 offset:12288
    ds_read_b128 v[92:95], v18 offset:12288
    s_waitcnt lgkmcnt(4)
    v_dot2_f32_bf16 v228, v64, v28, v228
    v_dot2_f32_bf16 v230, v64, v64, v230
    v_dot2_f32_bf16 v229, v65, v28, v229
    v_dot2_f32_bf16 v231, v65, v65, v231
    v_dot2_f32_bf16 v228, v66, v28, v228
    v_dot2_f32_bf16 v230, v66, v66, v230
    v_dot2_f32_bf16 v229, v67, v28, v229
    v_dot2_f32_bf16 v231, v67, v67, v231
    v_dot2_f32_bf16 v228, v68, v28, v228
    v_dot2_f32_bf16 v230, v68, v68, v230
    v_dot2_f32_bf16 v229, v69, v28, v229
    v_dot2_f32_bf16 v231, v69, v69, v231
    v_dot2_f32_bf16 v228, v70, v28, v228
    v_dot2_f32_bf16 v230, v70, v70, v230
    v_dot2_f32_bf16 v229, v71, v28, v229
    v_dot2_f32_bf16 v231, v71, v71, v231
    v_dot2_f32_bf16 v228, v72, v28, v228
    v_dot2_f32_bf16 v230, v72, v72, v230
    v_dot2_f32_bf16 v229, v73, v28, v229
    v_dot2_f32_bf16 v231, v73, v73, v231
    v_dot2_f32_bf16 v228, v74, v28, v228
    v_dot2_f32_bf16 v230, v74, v74, v230
    v_dot2_f32_bf16 v229, v75, v28, v229
    v_dot2_f32_bf16 v231, v75, v75, v231
    v_dot2_f32_bf16 v228, v76, v28, v228
    v_dot2_f32_bf16 v230, v76, v76, v230
    v_dot2_f32_bf16 v229, v77, v28, v229
    v_dot2_f32_bf16 v231, v77, v77, v231
    v_dot2_f32_bf16 v228, v78, v28, v228
    v_dot2_f32_bf16 v230, v78, v78, v230
    v_dot2_f32_bf16 v229, v79, v28, v229
    v_dot2_f32_bf16 v231, v79, v79, v231
    s_barrier
    ds_read_b128 v[96:99], v15 offset:16384
    ds_read_b128 v[100:103], v16 offset:16384
    ds_read_b128 v[104:107], v17 offset:16384
    ds_read_b128 v[108:111], v18 offset:16384
    s_waitcnt lgkmcnt(4)
    v_dot2_f32_bf16 v228, v80, v28, v228
    v_dot2_f32_bf16 v230, v80, v80, v230
    v_dot2_f32_bf16 v229, v81, v28, v229
    v_dot2_f32_bf16 v231, v81, v81, v231
    v_dot2_f32_bf16 v228, v82, v28, v228
    v_dot2_f32_bf16 v230, v82, v82, v230
    v_dot2_f32_bf16 v229, v83, v28, v229
    v_dot2_f32_bf16 v231, v83, v83, v231
    v_dot2_f32_bf16 v228, v84, v28, v228
    v_dot2_f32_bf16 v230, v84, v84, v230
    v_dot2_f32_bf16 v229, v85, v28, v229
    v_dot2_f32_bf16 v231, v85, v85, v231
    v_dot2_f32_bf16 v228, v86, v28, v228
    v_dot2_f32_bf16 v230, v86, v86, v230
    v_dot2_f32_bf16 v229, v87, v28, v229
    v_dot2_f32_bf16 v231, v87, v87, v231
    v_dot2_f32_bf16 v228, v88, v28, v228
    v_dot2_f32_bf16 v230, v88, v88, v230
    v_dot2_f32_bf16 v229, v89, v28, v229
    v_dot2_f32_bf16 v231, v89, v89, v231
    v_dot2_f32_bf16 v228, v90, v28, v228
    v_dot2_f32_bf16 v230, v90, v90, v230
    v_dot2_f32_bf16 v229, v91, v28, v229
    v_dot2_f32_bf16 v231, v91, v91, v231
    v_dot2_f32_bf16 v228, v92, v28, v228
    v_dot2_f32_bf16 v230, v92, v92, v230
    v_dot2_f32_bf16 v229, v93, v28, v229
    v_dot2_f32_bf16 v231, v93, v93, v231
    v_dot2_f32_bf16 v228, v94, v28, v228
    v_dot2_f32_bf16 v230, v94, v94, v230
    v_dot2_f32_bf16 v229, v95, v28, v229
    v_dot2_f32_bf16 v231, v95, v95, v231
    s_barrier
    ds_read_b128 v[112:115], v15 offset:20480
    ds_read_b128 v[116:119], v16 offset:20480
    ds_read_b128 v[120:123], v17 offset:20480
    ds_read_b128 v[124:127], v18 offset:20480
    s_waitcnt lgkmcnt(4)
    v_dot2_f32_bf16 v228, v96, v28, v228
    v_dot2_f32_bf16 v230, v96, v96, v230
    v_dot2_f32_bf16 v229, v97, v28, v229
    v_dot2_f32_bf16 v231, v97, v97, v231
    v_dot2_f32_bf16 v228, v98, v28, v228
    v_dot2_f32_bf16 v230, v98, v98, v230
    v_dot2_f32_bf16 v229, v99, v28, v229
    v_dot2_f32_bf16 v231, v99, v99, v231
    v_dot2_f32_bf16 v228, v100, v28, v228
    v_dot2_f32_bf16 v230, v100, v100, v230
    v_dot2_f32_bf16 v229, v101, v28, v229
    v_dot2_f32_bf16 v231, v101, v101, v231
    v_dot2_f32_bf16 v228, v102, v28, v228
    v_dot2_f32_bf16 v230, v102, v102, v230
    v_dot2_f32_bf16 v229, v103, v28, v229
    v_dot2_f32_bf16 v231, v103, v103, v231
    v_dot2_f32_bf16 v228, v104, v28, v228
    v_dot2_f32_bf16 v230, v104, v104, v230
    v_dot2_f32_bf16 v229, v105, v28, v229
    v_dot2_f32_bf16 v231, v105, v105, v231
    v_dot2_f32_bf16 v228, v106, v28, v228
    v_dot2_f32_bf16 v230, v106, v106, v230
    v_dot2_f32_bf16 v229, v107, v28, v229
    v_dot2_f32_bf16 v231, v107, v107, v231
    v_dot2_f32_bf16 v228, v108, v28, v228
    v_dot2_f32_bf16 v230, v108, v108, v230
    v_dot2_f32_bf16 v229, v109, v28, v229
    v_dot2_f32_bf16 v231, v109, v109, v231
    v_dot2_f32_bf16 v228, v110, v28, v228
    v_dot2_f32_bf16 v230, v110, v110, v230
    v_dot2_f32_bf16 v229, v111, v28, v229
    v_dot2_f32_bf16 v231, v111, v111, v231
    s_waitcnt lgkmcnt(0)
    v_dot2_f32_bf16 v228, v112, v28, v228
    v_dot2_f32_bf16 v230, v112, v112, v230
    v_dot2_f32_bf16 v229, v113, v28, v229
    v_dot2_f32_bf16 v231, v113, v113, v231
    v_dot2_f32_bf16 v228, v114, v28, v228
    v_dot2_f32_bf16 v230, v114, v114, v230
    v_dot2_f32_bf16 v229, v115, v28, v229
    v_dot2_f32_bf16 v231, v115, v115, v231
    v_dot2_f32_bf16 v228, v116, v28, v228
    v_dot2_f32_bf16 v230, v116, v116, v230
    v_dot2_f32_bf16 v229, v117, v28, v229
    v_dot2_f32_bf16 v231, v117, v117, v231
    v_dot2_f32_bf16 v228, v118, v28, v228
    v_dot2_f32_bf16 v230, v118, v118, v230
    v_dot2_f32_bf16 v229, v119, v28, v229
    v_dot2_f32_bf16 v231, v119, v119, v231
    v_dot2_f32_bf16 v228, v120, v28, v228
    v_dot2_f32_bf16 v230, v120, v120, v230
    v_dot2_f32_bf16 v229, v121, v28, v229
    v_dot2_f32_bf16 v231, v121, v121, v231
    v_dot2_f32_bf16 v228, v122, v28, v228
    v_dot2_f32_bf16 v230, v122, v122, v230
    v_dot2_f32_bf16 v229, v123, v28, v229
    v_dot2_f32_bf16 v231, v123, v123, v231
    v_dot2_f32_bf16 v228, v124, v28, v228
    v_dot2_f32_bf16 v230, v124, v124, v230
    v_dot2_f32_bf16 v229, v125, v28, v229
    v_dot2_f32_bf16 v231, v125, v125, v231
    v_dot2_f32_bf16 v228, v126, v28, v228
    v_dot2_f32_bf16 v230, v126, v126, v230
    v_dot2_f32_bf16 v229, v127, v28, v229
    v_dot2_f32_bf16 v231, v127, v127, v231
    s_nop 1
    v_add_f32 v228, v228, v229
    v_add_f32 v230, v230, v231
    v_mov_b32 v229, v228
    v_mov_b32 v231, v230
    s_nop 0
    v_permlane32_swap_b32 v228, v229
    v_permlane32_swap_b32 v230, v231
    v_add_f32 v228, v228, v229
    v_add_f32 v230, v230, v231
    s_mov_b32 s15, 991054117
    v_mul_f32 v228, s15, v228
    v_mul_f32 v230, s15, v230
    v_fma_f32 v230, -v228, v228, v230
    v_max_f32 v230, 0, v230
    v_add_f32 v230, 925353388, v230
    v_rsq_f32 v20, v230
    s_nop 0
    v_mul_f32 v22, -v228, v20
    s_waitcnt vmcnt(0)
    v_lshlrev_b32 v27, 16, v27
    v_lshlrev_b32 v3, 2, v0
    v_add_u32 v3, 155648, v3
    ds_write_b32 v3, v27
    s_mov_b32 s15, 0xffff0000
    v_lshlrev_b32 v228, 16, v32
    v_lshlrev_b32 v230, 16, v33
    v_lshlrev_b32 v232, 16, v34
    v_lshlrev_b32 v234, 16, v35
    v_and_b32 v229, s15, v32
    v_and_b32 v231, s15, v33
    v_and_b32 v233, s15, v34
    v_and_b32 v235, s15, v35
    v_pk_fma_f32 v[228:229], v[228:229], v[20:21], v[22:23] op_sel_hi:[1,0,0]
    v_pk_fma_f32 v[230:231], v[230:231], v[20:21], v[22:23] op_sel_hi:[1,0,0]
    v_pk_fma_f32 v[232:233], v[232:233], v[20:21], v[22:23] op_sel_hi:[1,0,0]
    v_pk_fma_f32 v[234:235], v[234:235], v[20:21], v[22:23] op_sel_hi:[1,0,0]
    v_cvt_pk_bf16_f32 v32, v228, v229
    v_cvt_pk_bf16_f32 v33, v230, v231
    v_cvt_pk_bf16_f32 v34, v232, v233
    v_cvt_pk_bf16_f32 v35, v234, v235
    v_lshlrev_b32 v236, 16, v36
    v_lshlrev_b32 v238, 16, v37
    v_lshlrev_b32 v240, 16, v38
    v_lshlrev_b32 v242, 16, v39
    v_and_b32 v237, s15, v36
    v_and_b32 v239, s15, v37
    v_and_b32 v241, s15, v38
    v_and_b32 v243, s15, v39
    v_pk_fma_f32 v[236:237], v[236:237], v[20:21], v[22:23] op_sel_hi:[1,0,0]
    v_pk_fma_f32 v[238:239], v[238:239], v[20:21], v[22:23] op_sel_hi:[1,0,0]
    v_pk_fma_f32 v[240:241], v[240:241], v[20:21], v[22:23] op_sel_hi:[1,0,0]
    v_pk_fma_f32 v[242:243], v[242:243], v[20:21], v[22:23] op_sel_hi:[1,0,0]
    v_cvt_pk_bf16_f32 v36, v236, v237
    v_cvt_pk_bf16_f32 v37, v238, v239
    v_cvt_pk_bf16_f32 v38, v240, v241
    v_cvt_pk_bf16_f32 v39, v242, v243
    v_lshlrev_b32 v228, 16, v40
    v_lshlrev_b32 v230, 16, v41
    v_lshlrev_b32 v232, 16, v42
    v_lshlrev_b32 v234, 16, v43
    v_and_b32 v229, s15, v40
    v_and_b32 v231, s15, v41
    v_and_b32 v233, s15, v42
    v_and_b32 v235, s15, v43
    v_pk_fma_f32 v[228:229], v[228:229], v[20:21], v[22:23] op_sel_hi:[1,0,0]
    v_pk_fma_f32 v[230:231], v[230:231], v[20:21], v[22:23] op_sel_hi:[1,0,0]
    v_pk_fma_f32 v[232:233], v[232:233], v[20:21], v[22:23] op_sel_hi:[1,0,0]
    v_pk_fma_f32 v[234:235], v[234:235], v[20:21], v[22:23] op_sel_hi:[1,0,0]
    v_cvt_pk_bf16_f32 v40, v228, v229
    v_cvt_pk_bf16_f32 v41, v230, v231
    v_cvt_pk_bf16_f32 v42, v232, v233
    v_cvt_pk_bf16_f32 v43, v234, v235
    v_lshlrev_b32 v236, 16, v44
    v_lshlrev_b32 v238, 16, v45
    v_lshlrev_b32 v240, 16, v46
    v_lshlrev_b32 v242, 16, v47
    v_and_b32 v237, s15, v44
    v_and_b32 v239, s15, v45
    v_and_b32 v241, s15, v46
    v_and_b32 v243, s15, v47
    v_pk_fma_f32 v[236:237], v[236:237], v[20:21], v[22:23] op_sel_hi:[1,0,0]
    v_pk_fma_f32 v[238:239], v[238:239], v[20:21], v[22:23] op_sel_hi:[1,0,0]
    v_pk_fma_f32 v[240:241], v[240:241], v[20:21], v[22:23] op_sel_hi:[1,0,0]
    v_pk_fma_f32 v[242:243], v[242:243], v[20:21], v[22:23] op_sel_hi:[1,0,0]
    v_cvt_pk_bf16_f32 v44, v236, v237
    v_cvt_pk_bf16_f32 v45, v238, v239
    v_cvt_pk_bf16_f32 v46, v240, v241
    v_cvt_pk_bf16_f32 v47, v242, v243
    v_lshlrev_b32 v228, 16, v48
    v_lshlrev_b32 v230, 16, v49
    v_lshlrev_b32 v232, 16, v50
    v_lshlrev_b32 v234, 16, v51
    v_and_b32 v229, s15, v48
    v_and_b32 v231, s15, v49
    v_and_b32 v233, s15, v50
    v_and_b32 v235, s15, v51
    v_pk_fma_f32 v[228:229], v[228:229], v[20:21], v[22:23] op_sel_hi:[1,0,0]
    v_pk_fma_f32 v[230:231], v[230:231], v[20:21], v[22:23] op_sel_hi:[1,0,0]
    v_pk_fma_f32 v[232:233], v[232:233], v[20:21], v[22:23] op_sel_hi:[1,0,0]
    v_pk_fma_f32 v[234:235], v[234:235], v[20:21], v[22:23] op_sel_hi:[1,0,0]
    v_cvt_pk_bf16_f32 v48, v228, v229
    v_cvt_pk_bf16_f32 v49, v230, v231
    v_cvt_pk_bf16_f32 v50, v232, v233
    v_cvt_pk_bf16_f32 v51, v234, v235
    v_lshlrev_b32 v236, 16, v52
    v_lshlrev_b32 v238, 16, v53
    v_lshlrev_b32 v240, 16, v54
    v_lshlrev_b32 v242, 16, v55
    v_and_b32 v237, s15, v52
    v_and_b32 v239, s15, v53
    v_and_b32 v241, s15, v54
    v_and_b32 v243, s15, v55
    v_pk_fma_f32 v[236:237], v[236:237], v[20:21], v[22:23] op_sel_hi:[1,0,0]
    v_pk_fma_f32 v[238:239], v[238:239], v[20:21], v[22:23] op_sel_hi:[1,0,0]
    v_pk_fma_f32 v[240:241], v[240:241], v[20:21], v[22:23] op_sel_hi:[1,0,0]
    v_pk_fma_f32 v[242:243], v[242:243], v[20:21], v[22:23] op_sel_hi:[1,0,0]
    v_cvt_pk_bf16_f32 v52, v236, v237
    v_cvt_pk_bf16_f32 v53, v238, v239
    v_cvt_pk_bf16_f32 v54, v240, v241
    v_cvt_pk_bf16_f32 v55, v242, v243
    v_lshlrev_b32 v228, 16, v56
    v_lshlrev_b32 v230, 16, v57
    v_lshlrev_b32 v232, 16, v58
    v_lshlrev_b32 v234, 16, v59
    v_and_b32 v229, s15, v56
    v_and_b32 v231, s15, v57
    v_and_b32 v233, s15, v58
    v_and_b32 v235, s15, v59
    v_pk_fma_f32 v[228:229], v[228:229], v[20:21], v[22:23] op_sel_hi:[1,0,0]
    v_pk_fma_f32 v[230:231], v[230:231], v[20:21], v[22:23] op_sel_hi:[1,0,0]
    v_pk_fma_f32 v[232:233], v[232:233], v[20:21], v[22:23] op_sel_hi:[1,0,0]
    v_pk_fma_f32 v[234:235], v[234:235], v[20:21], v[22:23] op_sel_hi:[1,0,0]
    v_cvt_pk_bf16_f32 v56, v228, v229
    v_cvt_pk_bf16_f32 v57, v230, v231
    v_cvt_pk_bf16_f32 v58, v232, v233
    v_cvt_pk_bf16_f32 v59, v234, v235
    v_lshlrev_b32 v236, 16, v60
    v_lshlrev_b32 v238, 16, v61
    v_lshlrev_b32 v240, 16, v62
    v_lshlrev_b32 v242, 16, v63
    v_and_b32 v237, s15, v60
    v_and_b32 v239, s15, v61
    v_and_b32 v241, s15, v62
    v_and_b32 v243, s15, v63
    v_pk_fma_f32 v[236:237], v[236:237], v[20:21], v[22:23] op_sel_hi:[1,0,0]
    v_pk_fma_f32 v[238:239], v[238:239], v[20:21], v[22:23] op_sel_hi:[1,0,0]
    v_pk_fma_f32 v[240:241], v[240:241], v[20:21], v[22:23] op_sel_hi:[1,0,0]
    v_pk_fma_f32 v[242:243], v[242:243], v[20:21], v[22:23] op_sel_hi:[1,0,0]
    v_cvt_pk_bf16_f32 v60, v236, v237
    v_cvt_pk_bf16_f32 v61, v238, v239
    v_cvt_pk_bf16_f32 v62, v240, v241
    v_cvt_pk_bf16_f32 v63, v242, v243
    v_lshlrev_b32 v228, 16, v64
    v_lshlrev_b32 v230, 16, v65
    v_lshlrev_b32 v232, 16, v66
    v_lshlrev_b32 v234, 16, v67
    v_and_b32 v229, s15, v64
    v_and_b32 v231, s15, v65
    v_and_b32 v233, s15, v66
    v_and_b32 v235, s15, v67
    v_pk_fma_f32 v[228:229], v[228:229], v[20:21], v[22:23] op_sel_hi:[1,0,0]
    v_pk_fma_f32 v[230:231], v[230:231], v[20:21], v[22:23] op_sel_hi:[1,0,0]
    v_pk_fma_f32 v[232:233], v[232:233], v[20:21], v[22:23] op_sel_hi:[1,0,0]
    v_pk_fma_f32 v[234:235], v[234:235], v[20:21], v[22:23] op_sel_hi:[1,0,0]
    v_cvt_pk_bf16_f32 v64, v228, v229
    v_cvt_pk_bf16_f32 v65, v230, v231
    v_cvt_pk_bf16_f32 v66, v232, v233
    v_cvt_pk_bf16_f32 v67, v234, v235
    v_lshlrev_b32 v236, 16, v68
    v_lshlrev_b32 v238, 16, v69
    v_lshlrev_b32 v240, 16, v70
    v_lshlrev_b32 v242, 16, v71
    v_and_b32 v237, s15, v68
    v_and_b32 v239, s15, v69
    v_and_b32 v241, s15, v70
    v_and_b32 v243, s15, v71
    v_pk_fma_f32 v[236:237], v[236:237], v[20:21], v[22:23] op_sel_hi:[1,0,0]
    v_pk_fma_f32 v[238:239], v[238:239], v[20:21], v[22:23] op_sel_hi:[1,0,0]
    v_pk_fma_f32 v[240:241], v[240:241], v[20:21], v[22:23] op_sel_hi:[1,0,0]
    v_pk_fma_f32 v[242:243], v[242:243], v[20:21], v[22:23] op_sel_hi:[1,0,0]
    v_cvt_pk_bf16_f32 v68, v236, v237
    v_cvt_pk_bf16_f32 v69, v238, v239
    v_cvt_pk_bf16_f32 v70, v240, v241
    v_cvt_pk_bf16_f32 v71, v242, v243
    v_lshlrev_b32 v228, 16, v72
    v_lshlrev_b32 v230, 16, v73
    v_lshlrev_b32 v232, 16, v74
    v_lshlrev_b32 v234, 16, v75
    v_and_b32 v229, s15, v72
    v_and_b32 v231, s15, v73
    v_and_b32 v233, s15, v74
    v_and_b32 v235, s15, v75
    v_pk_fma_f32 v[228:229], v[228:229], v[20:21], v[22:23] op_sel_hi:[1,0,0]
    v_pk_fma_f32 v[230:231], v[230:231], v[20:21], v[22:23] op_sel_hi:[1,0,0]
    v_pk_fma_f32 v[232:233], v[232:233], v[20:21], v[22:23] op_sel_hi:[1,0,0]
    v_pk_fma_f32 v[234:235], v[234:235], v[20:21], v[22:23] op_sel_hi:[1,0,0]
    v_cvt_pk_bf16_f32 v72, v228, v229
    v_cvt_pk_bf16_f32 v73, v230, v231
    v_cvt_pk_bf16_f32 v74, v232, v233
    v_cvt_pk_bf16_f32 v75, v234, v235
    v_lshlrev_b32 v236, 16, v76
    v_lshlrev_b32 v238, 16, v77
    v_lshlrev_b32 v240, 16, v78
    v_lshlrev_b32 v242, 16, v79
    v_and_b32 v237, s15, v76
    v_and_b32 v239, s15, v77
    v_and_b32 v241, s15, v78
    v_and_b32 v243, s15, v79
    v_pk_fma_f32 v[236:237], v[236:237], v[20:21], v[22:23] op_sel_hi:[1,0,0]
    v_pk_fma_f32 v[238:239], v[238:239], v[20:21], v[22:23] op_sel_hi:[1,0,0]
    v_pk_fma_f32 v[240:241], v[240:241], v[20:21], v[22:23] op_sel_hi:[1,0,0]
    v_pk_fma_f32 v[242:243], v[242:243], v[20:21], v[22:23] op_sel_hi:[1,0,0]
    v_cvt_pk_bf16_f32 v76, v236, v237
    v_cvt_pk_bf16_f32 v77, v238, v239
    v_cvt_pk_bf16_f32 v78, v240, v241
    v_cvt_pk_bf16_f32 v79, v242, v243
    v_lshlrev_b32 v228, 16, v80
    v_lshlrev_b32 v230, 16, v81
    v_lshlrev_b32 v232, 16, v82
    v_lshlrev_b32 v234, 16, v83
    v_and_b32 v229, s15, v80
    v_and_b32 v231, s15, v81
    v_and_b32 v233, s15, v82
    v_and_b32 v235, s15, v83
    v_pk_fma_f32 v[228:229], v[228:229], v[20:21], v[22:23] op_sel_hi:[1,0,0]
    v_pk_fma_f32 v[230:231], v[230:231], v[20:21], v[22:23] op_sel_hi:[1,0,0]
    v_pk_fma_f32 v[232:233], v[232:233], v[20:21], v[22:23] op_sel_hi:[1,0,0]
    v_pk_fma_f32 v[234:235], v[234:235], v[20:21], v[22:23] op_sel_hi:[1,0,0]
    v_cvt_pk_bf16_f32 v80, v228, v229
    v_cvt_pk_bf16_f32 v81, v230, v231
    v_cvt_pk_bf16_f32 v82, v232, v233
    v_cvt_pk_bf16_f32 v83, v234, v235
    v_lshlrev_b32 v236, 16, v84
    v_lshlrev_b32 v238, 16, v85
    v_lshlrev_b32 v240, 16, v86
    v_lshlrev_b32 v242, 16, v87
    v_and_b32 v237, s15, v84
    v_and_b32 v239, s15, v85
    v_and_b32 v241, s15, v86
    v_and_b32 v243, s15, v87
    v_pk_fma_f32 v[236:237], v[236:237], v[20:21], v[22:23] op_sel_hi:[1,0,0]
    v_pk_fma_f32 v[238:239], v[238:239], v[20:21], v[22:23] op_sel_hi:[1,0,0]
    v_pk_fma_f32 v[240:241], v[240:241], v[20:21], v[22:23] op_sel_hi:[1,0,0]
    v_pk_fma_f32 v[242:243], v[242:243], v[20:21], v[22:23] op_sel_hi:[1,0,0]
    v_cvt_pk_bf16_f32 v84, v236, v237
    v_cvt_pk_bf16_f32 v85, v238, v239
    v_cvt_pk_bf16_f32 v86, v240, v241
    v_cvt_pk_bf16_f32 v87, v242, v243
    v_lshlrev_b32 v228, 16, v88
    v_lshlrev_b32 v230, 16, v89
    v_lshlrev_b32 v232, 16, v90
    v_lshlrev_b32 v234, 16, v91
    v_and_b32 v229, s15, v88
    v_and_b32 v231, s15, v89
    v_and_b32 v233, s15, v90
    v_and_b32 v235, s15, v91
    v_pk_fma_f32 v[228:229], v[228:229], v[20:21], v[22:23] op_sel_hi:[1,0,0]
    v_pk_fma_f32 v[230:231], v[230:231], v[20:21], v[22:23] op_sel_hi:[1,0,0]
    v_pk_fma_f32 v[232:233], v[232:233], v[20:21], v[22:23] op_sel_hi:[1,0,0]
    v_pk_fma_f32 v[234:235], v[234:235], v[20:21], v[22:23] op_sel_hi:[1,0,0]
    v_cvt_pk_bf16_f32 v88, v228, v229
    v_cvt_pk_bf16_f32 v89, v230, v231
    v_cvt_pk_bf16_f32 v90, v232, v233
    v_cvt_pk_bf16_f32 v91, v234, v235
    v_lshlrev_b32 v236, 16, v92
    v_lshlrev_b32 v238, 16, v93
    v_lshlrev_b32 v240, 16, v94
    v_lshlrev_b32 v242, 16, v95
    v_and_b32 v237, s15, v92
    v_and_b32 v239, s15, v93
    v_and_b32 v241, s15, v94
    v_and_b32 v243, s15, v95
    v_pk_fma_f32 v[236:237], v[236:237], v[20:21], v[22:23] op_sel_hi:[1,0,0]
    v_pk_fma_f32 v[238:239], v[238:239], v[20:21], v[22:23] op_sel_hi:[1,0,0]
    v_pk_fma_f32 v[240:241], v[240:241], v[20:21], v[22:23] op_sel_hi:[1,0,0]
    v_pk_fma_f32 v[242:243], v[242:243], v[20:21], v[22:23] op_sel_hi:[1,0,0]
    v_cvt_pk_bf16_f32 v92, v236, v237
    v_cvt_pk_bf16_f32 v93, v238, v239
    v_cvt_pk_bf16_f32 v94, v240, v241
    v_cvt_pk_bf16_f32 v95, v242, v243
    v_lshlrev_b32 v228, 16, v96
    v_lshlrev_b32 v230, 16, v97
    v_lshlrev_b32 v232, 16, v98
    v_lshlrev_b32 v234, 16, v99
    v_and_b32 v229, s15, v96
    v_and_b32 v231, s15, v97
    v_and_b32 v233, s15, v98
    v_and_b32 v235, s15, v99
    v_pk_fma_f32 v[228:229], v[228:229], v[20:21], v[22:23] op_sel_hi:[1,0,0]
    v_pk_fma_f32 v[230:231], v[230:231], v[20:21], v[22:23] op_sel_hi:[1,0,0]
    v_pk_fma_f32 v[232:233], v[232:233], v[20:21], v[22:23] op_sel_hi:[1,0,0]
    v_pk_fma_f32 v[234:235], v[234:235], v[20:21], v[22:23] op_sel_hi:[1,0,0]
    v_cvt_pk_bf16_f32 v96, v228, v229
    v_cvt_pk_bf16_f32 v97, v230, v231
    v_cvt_pk_bf16_f32 v98, v232, v233
    v_cvt_pk_bf16_f32 v99, v234, v235
    v_lshlrev_b32 v236, 16, v100
    v_lshlrev_b32 v238, 16, v101
    v_lshlrev_b32 v240, 16, v102
    v_lshlrev_b32 v242, 16, v103
    v_and_b32 v237, s15, v100
    v_and_b32 v239, s15, v101
    v_and_b32 v241, s15, v102
    v_and_b32 v243, s15, v103
    v_pk_fma_f32 v[236:237], v[236:237], v[20:21], v[22:23] op_sel_hi:[1,0,0]
    v_pk_fma_f32 v[238:239], v[238:239], v[20:21], v[22:23] op_sel_hi:[1,0,0]
    v_pk_fma_f32 v[240:241], v[240:241], v[20:21], v[22:23] op_sel_hi:[1,0,0]
    v_pk_fma_f32 v[242:243], v[242:243], v[20:21], v[22:23] op_sel_hi:[1,0,0]
    v_cvt_pk_bf16_f32 v100, v236, v237
    v_cvt_pk_bf16_f32 v101, v238, v239
    v_cvt_pk_bf16_f32 v102, v240, v241
    v_cvt_pk_bf16_f32 v103, v242, v243
    v_lshlrev_b32 v228, 16, v104
    v_lshlrev_b32 v230, 16, v105
    v_lshlrev_b32 v232, 16, v106
    v_lshlrev_b32 v234, 16, v107
    v_and_b32 v229, s15, v104
    v_and_b32 v231, s15, v105
    v_and_b32 v233, s15, v106
    v_and_b32 v235, s15, v107
    v_pk_fma_f32 v[228:229], v[228:229], v[20:21], v[22:23] op_sel_hi:[1,0,0]
    v_pk_fma_f32 v[230:231], v[230:231], v[20:21], v[22:23] op_sel_hi:[1,0,0]
    v_pk_fma_f32 v[232:233], v[232:233], v[20:21], v[22:23] op_sel_hi:[1,0,0]
    v_pk_fma_f32 v[234:235], v[234:235], v[20:21], v[22:23] op_sel_hi:[1,0,0]
    v_cvt_pk_bf16_f32 v104, v228, v229
    v_cvt_pk_bf16_f32 v105, v230, v231
    v_cvt_pk_bf16_f32 v106, v232, v233
    v_cvt_pk_bf16_f32 v107, v234, v235
    v_lshlrev_b32 v236, 16, v108
    v_lshlrev_b32 v238, 16, v109
    v_lshlrev_b32 v240, 16, v110
    v_lshlrev_b32 v242, 16, v111
    v_and_b32 v237, s15, v108
    v_and_b32 v239, s15, v109
    v_and_b32 v241, s15, v110
    v_and_b32 v243, s15, v111
    v_pk_fma_f32 v[236:237], v[236:237], v[20:21], v[22:23] op_sel_hi:[1,0,0]
    v_pk_fma_f32 v[238:239], v[238:239], v[20:21], v[22:23] op_sel_hi:[1,0,0]
    v_pk_fma_f32 v[240:241], v[240:241], v[20:21], v[22:23] op_sel_hi:[1,0,0]
    v_pk_fma_f32 v[242:243], v[242:243], v[20:21], v[22:23] op_sel_hi:[1,0,0]
    v_cvt_pk_bf16_f32 v108, v236, v237
    v_cvt_pk_bf16_f32 v109, v238, v239
    v_cvt_pk_bf16_f32 v110, v240, v241
    v_cvt_pk_bf16_f32 v111, v242, v243
    v_lshlrev_b32 v228, 16, v112
    v_lshlrev_b32 v230, 16, v113
    v_lshlrev_b32 v232, 16, v114
    v_lshlrev_b32 v234, 16, v115
    v_and_b32 v229, s15, v112
    v_and_b32 v231, s15, v113
    v_and_b32 v233, s15, v114
    v_and_b32 v235, s15, v115
    v_pk_fma_f32 v[228:229], v[228:229], v[20:21], v[22:23] op_sel_hi:[1,0,0]
    v_pk_fma_f32 v[230:231], v[230:231], v[20:21], v[22:23] op_sel_hi:[1,0,0]
    v_pk_fma_f32 v[232:233], v[232:233], v[20:21], v[22:23] op_sel_hi:[1,0,0]
    v_pk_fma_f32 v[234:235], v[234:235], v[20:21], v[22:23] op_sel_hi:[1,0,0]
    v_cvt_pk_bf16_f32 v112, v228, v229
    v_cvt_pk_bf16_f32 v113, v230, v231
    v_cvt_pk_bf16_f32 v114, v232, v233
    v_cvt_pk_bf16_f32 v115, v234, v235
    v_lshlrev_b32 v236, 16, v116
    v_lshlrev_b32 v238, 16, v117
    v_lshlrev_b32 v240, 16, v118
    v_lshlrev_b32 v242, 16, v119
    v_and_b32 v237, s15, v116
    v_and_b32 v239, s15, v117
    v_and_b32 v241, s15, v118
    v_and_b32 v243, s15, v119
    v_pk_fma_f32 v[236:237], v[236:237], v[20:21], v[22:23] op_sel_hi:[1,0,0]
    v_pk_fma_f32 v[238:239], v[238:239], v[20:21], v[22:23] op_sel_hi:[1,0,0]
    v_pk_fma_f32 v[240:241], v[240:241], v[20:21], v[22:23] op_sel_hi:[1,0,0]
    v_pk_fma_f32 v[242:243], v[242:243], v[20:21], v[22:23] op_sel_hi:[1,0,0]
    v_cvt_pk_bf16_f32 v116, v236, v237
    v_cvt_pk_bf16_f32 v117, v238, v239
    v_cvt_pk_bf16_f32 v118, v240, v241
    v_cvt_pk_bf16_f32 v119, v242, v243
    v_lshlrev_b32 v228, 16, v120
    v_lshlrev_b32 v230, 16, v121
    v_lshlrev_b32 v232, 16, v122
    v_lshlrev_b32 v234, 16, v123
    v_and_b32 v229, s15, v120
    v_and_b32 v231, s15, v121
    v_and_b32 v233, s15, v122
    v_and_b32 v235, s15, v123
    v_pk_fma_f32 v[228:229], v[228:229], v[20:21], v[22:23] op_sel_hi:[1,0,0]
    v_pk_fma_f32 v[230:231], v[230:231], v[20:21], v[22:23] op_sel_hi:[1,0,0]
    v_pk_fma_f32 v[232:233], v[232:233], v[20:21], v[22:23] op_sel_hi:[1,0,0]
    v_pk_fma_f32 v[234:235], v[234:235], v[20:21], v[22:23] op_sel_hi:[1,0,0]
    v_cvt_pk_bf16_f32 v120, v228, v229
    v_cvt_pk_bf16_f32 v121, v230, v231
    v_cvt_pk_bf16_f32 v122, v232, v233
    v_cvt_pk_bf16_f32 v123, v234, v235
    v_lshlrev_b32 v236, 16, v124
    v_lshlrev_b32 v238, 16, v125
    v_lshlrev_b32 v240, 16, v126
    v_lshlrev_b32 v242, 16, v127
    v_and_b32 v237, s15, v124
    v_and_b32 v239, s15, v125
    v_and_b32 v241, s15, v126
    v_and_b32 v243, s15, v127
    v_pk_fma_f32 v[236:237], v[236:237], v[20:21], v[22:23] op_sel_hi:[1,0,0]
    v_pk_fma_f32 v[238:239], v[238:239], v[20:21], v[22:23] op_sel_hi:[1,0,0]
    v_pk_fma_f32 v[240:241], v[240:241], v[20:21], v[22:23] op_sel_hi:[1,0,0]
    v_pk_fma_f32 v[242:243], v[242:243], v[20:21], v[22:23] op_sel_hi:[1,0,0]
    v_cvt_pk_bf16_f32 v124, v236, v237
    v_cvt_pk_bf16_f32 v125, v238, v239
    v_cvt_pk_bf16_f32 v126, v240, v241
    v_cvt_pk_bf16_f32 v127, v242, v243
    v_lshlrev_b32 v228, 16, v128
    v_lshlrev_b32 v230, 16, v129
    v_lshlrev_b32 v232, 16, v130
    v_lshlrev_b32 v234, 16, v131
    v_and_b32 v229, s15, v128
    v_and_b32 v231, s15, v129
    v_and_b32 v233, s15, v130
    v_and_b32 v235, s15, v131
    v_pk_fma_f32 v[228:229], v[228:229], v[20:21], v[22:23] op_sel_hi:[1,0,0]
    v_pk_fma_f32 v[230:231], v[230:231], v[20:21], v[22:23] op_sel_hi:[1,0,0]
    v_pk_fma_f32 v[232:233], v[232:233], v[20:21], v[22:23] op_sel_hi:[1,0,0]
    v_pk_fma_f32 v[234:235], v[234:235], v[20:21], v[22:23] op_sel_hi:[1,0,0]
    v_cvt_pk_bf16_f32 v128, v228, v229
    v_cvt_pk_bf16_f32 v129, v230, v231
    v_cvt_pk_bf16_f32 v130, v232, v233
    v_cvt_pk_bf16_f32 v131, v234, v235
    v_lshlrev_b32 v236, 16, v132
    v_lshlrev_b32 v238, 16, v133
    v_lshlrev_b32 v240, 16, v134
    v_lshlrev_b32 v242, 16, v135
    v_and_b32 v237, s15, v132
    v_and_b32 v239, s15, v133
    v_and_b32 v241, s15, v134
    v_and_b32 v243, s15, v135
    v_pk_fma_f32 v[236:237], v[236:237], v[20:21], v[22:23] op_sel_hi:[1,0,0]
    v_pk_fma_f32 v[238:239], v[238:239], v[20:21], v[22:23] op_sel_hi:[1,0,0]
    v_pk_fma_f32 v[240:241], v[240:241], v[20:21], v[22:23] op_sel_hi:[1,0,0]
    v_pk_fma_f32 v[242:243], v[242:243], v[20:21], v[22:23] op_sel_hi:[1,0,0]
    v_cvt_pk_bf16_f32 v132, v236, v237
    v_cvt_pk_bf16_f32 v133, v238, v239
    v_cvt_pk_bf16_f32 v134, v240, v241
    v_cvt_pk_bf16_f32 v135, v242, v243
    v_lshlrev_b32 v228, 16, v136
    v_lshlrev_b32 v230, 16, v137
    v_lshlrev_b32 v232, 16, v138
    v_lshlrev_b32 v234, 16, v139
    v_and_b32 v229, s15, v136
    v_and_b32 v231, s15, v137
    v_and_b32 v233, s15, v138
    v_and_b32 v235, s15, v139
    v_pk_fma_f32 v[228:229], v[228:229], v[20:21], v[22:23] op_sel_hi:[1,0,0]
    v_pk_fma_f32 v[230:231], v[230:231], v[20:21], v[22:23] op_sel_hi:[1,0,0]
    v_pk_fma_f32 v[232:233], v[232:233], v[20:21], v[22:23] op_sel_hi:[1,0,0]
    v_pk_fma_f32 v[234:235], v[234:235], v[20:21], v[22:23] op_sel_hi:[1,0,0]
    v_cvt_pk_bf16_f32 v136, v228, v229
    v_cvt_pk_bf16_f32 v137, v230, v231
    v_cvt_pk_bf16_f32 v138, v232, v233
    v_cvt_pk_bf16_f32 v139, v234, v235
    v_lshlrev_b32 v236, 16, v140
    v_lshlrev_b32 v238, 16, v141
    v_lshlrev_b32 v240, 16, v142
    v_lshlrev_b32 v242, 16, v143
    v_and_b32 v237, s15, v140
    v_and_b32 v239, s15, v141
    v_and_b32 v241, s15, v142
    v_and_b32 v243, s15, v143
    v_pk_fma_f32 v[236:237], v[236:237], v[20:21], v[22:23] op_sel_hi:[1,0,0]
    v_pk_fma_f32 v[238:239], v[238:239], v[20:21], v[22:23] op_sel_hi:[1,0,0]
    v_pk_fma_f32 v[240:241], v[240:241], v[20:21], v[22:23] op_sel_hi:[1,0,0]
    v_pk_fma_f32 v[242:243], v[242:243], v[20:21], v[22:23] op_sel_hi:[1,0,0]
    v_cvt_pk_bf16_f32 v140, v236, v237
    v_cvt_pk_bf16_f32 v141, v238, v239
    v_cvt_pk_bf16_f32 v142, v240, v241
    v_cvt_pk_bf16_f32 v143, v242, v243
    s_mov_b32 s22, 0
    s_mov_b32 s27, 0
    s_mov_b32 s31, 1049335798
    v_mov_b32 v8, v7
    s_waitcnt lgkmcnt(0)
    s_barrier
    ds_read_b64_tr_b16 v[176:177], v8 offset:0
    ds_read_b64_tr_b16 v[178:179], v8 offset:512
    ds_read_b64_tr_b16 v[180:181], v8 offset:2048
    ds_read_b64_tr_b16 v[182:183], v8 offset:2560
    ds_read_b64_tr_b16 v[184:185], v8 offset:4096
    ds_read_b64_tr_b16 v[186:187], v8 offset:4608
    ds_read_b64_tr_b16 v[188:189], v8 offset:6144
    ds_read_b64_tr_b16 v[190:191], v8 offset:6656
    ds_read_b64_tr_b16 v[192:193], v8 offset:8192
    ds_read_b64_tr_b16 v[194:195], v8 offset:8704
    ds_read_b64_tr_b16 v[196:197], v8 offset:10240
    ds_read_b64_tr_b16 v[198:199], v8 offset:10752
.p2align 6
C_DISP:
    s_lshr_b32 s85, s22, 1
    s_lshl_b32 s17, s85, 3
    s_lshr_b32 s37, s18, s17
    s_cmp_ge_u32 s85, 4
    s_cselect_b32 s37, 3, s37
    s_and_b32 s62, s37, 3
    s_bfe_u32 s39, s37, 0x60002
    s_cmp_lt_u32 s39, 7
    s_cselect_b32 s38, 1, 0
    s_cmp_eq_u32 s62, 0
    s_cselect_b32 s38, s38, 0
    s_cbranch_scc1 C_T
    s_cmp_eq_u32 s62, 1
    s_cbranch_scc1 C_V
C_M:
    s_waitcnt lgkmcnt(8)
    v_mfma_f32_32x32x16_bf16 v[144:159], v[176:179], v[32:35], v[204:219]
    ds_read_b64_tr_b16 v[200:201], v8 offset:12288
    ds_read_b64_tr_b16 v[202:203], v8 offset:12800
    v_mfma_f32_32x32x16_bf16 v[144:159], v[180:183], v[36:39], v[144:159]
    ds_read_b64_tr_b16 v[176:177], v8 offset:14336
    ds_read_b64_tr_b16 v[178:179], v8 offset:14848
    s_cmp_eq_u32 s27, 0
    s_cbranch_scc1 NS1
    v_mul_f32 v160, s31, v160
    v_mul_f32 v161, s31, v161
    v_mul_f32 v162, s31, v162
    v_mul_f32 v163, s31, v163
    v_mul_f32 v164, s31, v164
    v_mul_f32 v165, s31, v165
    v_mul_f32 v166, s31, v166
    v_mul_f32 v167, s31, v167
    v_mul_f32 v168, s31, v168
    v_mul_f32 v169, s31, v169
    v_mul_f32 v170, s31, v170
    v_mul_f32 v171, s31, v171
    v_mul_f32 v172, s31, v172
    v_mul_f32 v173, s31, v173
    v_mul_f32 v174, s31, v174
    v_mul_f32 v175, s31, v175
NS1:
    v_cvt_pk_bf16_f32 v220, v160, v161
    v_cvt_pk_bf16_f32 v221, v162, v163
    v_cvt_pk_bf16_f32 v222, v164, v165
    v_cvt_pk_bf16_f32 v223, v166, v167
    s_waitcnt lgkmcnt(8)
    v_mfma_f32_32x32x16_bf16 v[144:159], v[184:187], v[40:43], v[144:159]
    ds_read_b64_tr_b16 v[180:181], v8 offset:16384
    ds_read_b64_tr_b16 v[182:183], v8 offset:16896
    v_cvt_pk_bf16_f32 v224, v168, v169
    v_cvt_pk_bf16_f32 v225, v170, v171
    v_cvt_pk_bf16_f32 v226, v172, v173
    v_cvt_pk_bf16_f32 v227, v174, v175
    v_mfma_f32_32x32x16_bf16 v[144:159], v[188:191], v[44:47], v[144:159]
    ds_read_b64_tr_b16 v[184:185], v8 offset:18432
    ds_read_b64_tr_b16 v[186:187], v8 offset:18944
    ds_write_b128 v6, v[220:223] offset:2048
    ds_write_b128 v6, v[224:227] offset:3072
    s_mov_b32 s27, s38
    s_waitcnt lgkmcnt(10)
    v_mfma_f32_32x32x16_bf16 v[144:159], v[192:195], v[48:51], v[144:159]
    ds_read_b64_tr_b16 v[188:189], v8 offset:20480
    ds_read_b64_tr_b16 v[190:191], v8 offset:20992
    v_mfma_f32_32x32x16_bf16 v[144:159], v[196:199], v[52:55], v[144:159]
    ds_read_b64_tr_b16 v[192:193], v8 offset:22528
    ds_read_b64_tr_b16 v[194:195], v8 offset:23040
    s_waitcnt lgkmcnt(10)
    v_mfma_f32_32x32x16_bf16 v[144:159], v[200:203], v[56:59], v[144:159]
    ds_read_b64_tr_b16 v[196:197], v8 offset:24576
    ds_read_b64_tr_b16 v[198:199], v8 offset:25088
    s_waitcnt lgkmcnt(6)
    s_barrier
    s_add_u32 s16, s22, 1
    s_and_b32 s24, s16, 1
    v_mfma_f32_32x32x16_bf16 v[144:159], v[176:179], v[60:63], v[144:159]
    ds_read_b64_tr_b16 v[200:201], v8 offset:26624
    ds_read_b64_tr_b16 v[202:203], v8 offset:27136
    s_and_b32 s17, s13, 1
    s_cmp_eq_u32 s16, 6
    s_waitcnt lgkmcnt(10)
    v_mfma_f32_32x32x16_bf16 v[144:159], v[180:183], v[64:67], v[144:159]
    ds_read_b64_tr_b16 v[176:177], v8 offset:28672
    ds_read_b64_tr_b16 v[178:179], v8 offset:29184
    s_cselect_b32 s24, s17, s24
    v_mfma_f32_32x32x16_bf16 v[144:159], v[184:187], v[68:71], v[144:159]
    ds_read_b64_tr_b16 v[180:181], v8 offset:30720
    ds_read_b64_tr_b16 v[182:183], v8 offset:31232
    s_lshl_b32 s15, s24, 6
    s_waitcnt lgkmcnt(8)
    v_mfma_f32_32x32x16_bf16 v[144:159], v[188:191], v[72:75], v[144:159]
    ds_read_b64_tr_b16 v[184:185], v8 offset:32768
    ds_read_b64_tr_b16 v[186:187], v8 offset:33280
    v_xor_b32 v19, s15, v7
    v_mfma_f32_32x32x16_bf16 v[144:159], v[192:195], v[76:79], v[144:159]
    ds_read_b64_tr_b16 v[188:189], v8 offset:34816
    ds_read_b64_tr_b16 v[190:191], v8 offset:35328
    s_bfe_u32 s15, s16, 0x10001
    s_waitcnt lgkmcnt(8)
    v_mfma_f32_32x32x16_bf16 v[144:159], v[196:199], v[80:83], v[144:159]
    ds_read_b64_tr_b16 v[192:193], v8 offset:36864
    ds_read_b64_tr_b16 v[194:195], v8 offset:37376
    s_mul_i32 s15, s15, 57344
    v_mfma_f32_32x32x16_bf16 v[144:159], v[200:203], v[84:87], v[144:159]
    ds_read_b64_tr_b16 v[196:197], v8 offset:38912
    ds_read_b64_tr_b16 v[198:199], v8 offset:39424
    v_add_u32 v19, s15, v19
    s_waitcnt lgkmcnt(8)
    v_mfma_f32_32x32x16_bf16 v[144:159], v[176:179], v[88:91], v[144:159]
    ds_read_b64_tr_b16 v[200:201], v8 offset:40960
    ds_read_b64_tr_b16 v[202:203], v8 offset:41472
    s_lshl_b32 s15, s16, 7
    v_mfma_f32_32x32x16_bf16 v[144:159], v[180:183], v[92:95], v[144:159]
    ds_read_b64_tr_b16 v[176:177], v8 offset:43008
    ds_read_b64_tr_b16 v[178:179], v8 offset:43520
    v_add_u32 v27, s15, v29
    s_waitcnt lgkmcnt(8)
    v_mfma_f32_32x32x16_bf16 v[144:159], v[184:187], v[96:99], v[144:159]
    ds_read_b64_tr_b16 v[180:181], v8 offset:45056
    ds_read_b64_tr_b16 v[182:183], v8 offset:45568
    s_add_u32 s22, s22, 1
    v_mfma_f32_32x32x16_bf16 v[144:159], v[188:191], v[100:103], v[144:159]
    ds_read_b64_tr_b16 v[184:185], v8 offset:47104
    ds_read_b64_tr_b16 v[186:187], v8 offset:47616
    s_waitcnt lgkmcnt(8)
    v_mfma_f32_32x32x16_bf16 v[144:159], v[192:195], v[104:107], v[144:159]
    ds_read_b64_tr_b16 v[188:189], v8 offset:49152
    ds_read_b64_tr_b16 v[190:191], v8 offset:49664
    v_mfma_f32_32x32x16_bf16 v[144:159], v[196:199], v[108:111], v[144:159]
    ds_read_b64_tr_b16 v[192:193], v8 offset:51200
    ds_read_b64_tr_b16 v[194:195], v8 offset:51712
    s_waitcnt lgkmcnt(8)
    v_mfma_f32_32x32x16_bf16 v[144:159], v[200:203], v[112:115], v[144:159]
    ds_read_b64_tr_b16 v[196:197], v8 offset:53248
    ds_read_b64_tr_b16 v[198:199], v8 offset:53760
    v_mfma_f32_32x32x16_bf16 v[144:159], v[176:179], v[116:119], v[144:159]
    ds_read_b64_tr_b16 v[200:201], v8 offset:55296
    ds_read_b64_tr_b16 v[202:203], v8 offset:55808
    ds_read_b128 v[204:207], v27 offset:0
    ds_read_b128 v[208:211], v27 offset:32
    ds_read_b128 v[212:215], v27 offset:64
    ds_read_b128 v[216:219], v27 offset:96
    s_waitcnt lgkmcnt(12)
    v_mfma_f32_32x32x16_bf16 v[144:159], v[180:183], v[120:123], v[144:159]
    ds_read_b64_tr_b16 v[176:177], v19 offset:0
    ds_read_b64_tr_b16 v[178:179], v19 offset:512
    v_mfma_f32_32x32x16_bf16 v[144:159], v[184:187], v[124:127], v[144:159]
    ds_read_b64_tr_b16 v[180:181], v19 offset:2048
    ds_read_b64_tr_b16 v[182:183], v19 offset:2560
    s_waitcnt lgkmcnt(12)
    v_mfma_f32_32x32x16_bf16 v[144:159], v[188:191], v[128:131], v[144:159]
    ds_read_b64_tr_b16 v[184:185], v19 offset:4096
    ds_read_b64_tr_b16 v[186:187], v19 offset:4608
    v_mfma_f32_32x32x16_bf16 v[144:159], v[192:195], v[132:135], v[144:159]
    ds_read_b64_tr_b16 v[188:189], v19 offset:6144
    ds_read_b64_tr_b16 v[190:191], v19 offset:6656
    s_waitcnt lgkmcnt(12)
    v_mfma_f32_32x32x16_bf16 v[144:159], v[196:199], v[136:139], v[144:159]
    ds_read_b64_tr_b16 v[192:193], v19 offset:8192
    ds_read_b64_tr_b16 v[194:195], v19 offset:8704
    v_mfma_f32_32x32x16_bf16 v[160:175], v[200:203], v[140:143], v[144:159]
    ds_read_b64_tr_b16 v[196:197], v19 offset:10240
    ds_read_b64_tr_b16 v[198:199], v19 offset:10752
    s_cmp_ge_u32 s22, s19
    s_cbranch_scc1 C_DONE_E
    s_waitcnt lgkmcnt(8)
    v_mfma_f32_32x32x16_bf16 v[144:159], v[176:179], v[32:35], v[204:219]
    ds_read_b64_tr_b16 v[200:201], v19 offset:12288
    ds_read_b64_tr_b16 v[202:203], v19 offset:12800
    v_mfma_f32_32x32x16_bf16 v[144:159], v[180:183], v[36:39], v[144:159]
    ds_read_b64_tr_b16 v[176:177], v19 offset:14336
    ds_read_b64_tr_b16 v[178:179], v19 offset:14848
    s_cmp_eq_u32 s27, 0
    s_cbranch_scc1 NS2
    v_mul_f32 v160, s31, v160
    v_mul_f32 v161, s31, v161
    v_mul_f32 v162, s31, v162
    v_mul_f32 v163, s31, v163
    v_mul_f32 v164, s31, v164
    v_mul_f32 v165, s31, v165
    v_mul_f32 v166, s31, v166
    v_mul_f32 v167, s31, v167
    v_mul_f32 v168, s31, v168
    v_mul_f32 v169, s31, v169
    v_mul_f32 v170, s31, v170
    v_mul_f32 v171, s31, v171
    v_mul_f32 v172, s31, v172
    v_mul_f32 v173, s31, v173
    v_mul_f32 v174, s31, v174
    v_mul_f32 v175, s31, v175
NS2:
    v_cvt_pk_bf16_f32 v220, v160, v161
    v_cvt_pk_bf16_f32 v221, v162, v163
    v_cvt_pk_bf16_f32 v222, v164, v165
    v_cvt_pk_bf16_f32 v223, v166, v167
    s_waitcnt lgkmcnt(8)
    v_mfma_f32_32x32x16_bf16 v[144:159], v[184:187], v[40:43], v[144:159]
    ds_read_b64_tr_b16 v[180:181], v19 offset:16384
    ds_read_b64_tr_b16 v[182:183], v19 offset:16896
    v_cvt_pk_bf16_f32 v224, v168, v169
    v_cvt_pk_bf16_f32 v225, v170, v171
    v_cvt_pk_bf16_f32 v226, v172, v173
    v_cvt_pk_bf16_f32 v227, v174, v175
    v_mfma_f32_32x32x16_bf16 v[144:159], v[188:191], v[44:47], v[144:159]
    ds_read_b64_tr_b16 v[184:185], v19 offset:18432
    ds_read_b64_tr_b16 v[186:187], v19 offset:18944
    ds_write_b128 v6, v[220:223] offset:0
    ds_write_b128 v6, v[224:227] offset:1024
    s_mov_b32 s27, s38
    s_waitcnt lgkmcnt(10)
    v_mfma_f32_32x32x16_bf16 v[144:159], v[192:195], v[48:51], v[144:159]
    ds_read_b64_tr_b16 v[188:189], v19 offset:20480
    ds_read_b64_tr_b16 v[190:191], v19 offset:20992
    v_mfma_f32_32x32x16_bf16 v[144:159], v[196:199], v[52:55], v[144:159]
    ds_read_b64_tr_b16 v[192:193], v19 offset:22528
    ds_read_b64_tr_b16 v[194:195], v19 offset:23040
    s_waitcnt lgkmcnt(10)
    v_mfma_f32_32x32x16_bf16 v[144:159], v[200:203], v[56:59], v[144:159]
    ds_read_b64_tr_b16 v[196:197], v19 offset:24576
    ds_read_b64_tr_b16 v[198:199], v19 offset:25088
    s_add_u32 s16, s22, 1
    s_and_b32 s24, s16, 1
    v_mfma_f32_32x32x16_bf16 v[144:159], v[176:179], v[60:63], v[144:159]
    ds_read_b64_tr_b16 v[200:201], v19 offset:26624
    ds_read_b64_tr_b16 v[202:203], v19 offset:27136
    s_and_b32 s17, s13, 1
    s_cmp_eq_u32 s16, 6
    s_waitcnt lgkmcnt(10)
    v_mfma_f32_32x32x16_bf16 v[144:159], v[180:183], v[64:67], v[144:159]
    ds_read_b64_tr_b16 v[176:177], v19 offset:28672
    ds_read_b64_tr_b16 v[178:179], v19 offset:29184
    s_cselect_b32 s24, s17, s24
    v_mfma_f32_32x32x16_bf16 v[144:159], v[184:187], v[68:71], v[144:159]
    ds_read_b64_tr_b16 v[180:181], v19 offset:30720
    ds_read_b64_tr_b16 v[182:183], v19 offset:31232
    s_lshl_b32 s15, s24, 6
    s_waitcnt lgkmcnt(8)
    v_mfma_f32_32x32x16_bf16 v[144:159], v[188:191], v[72:75], v[144:159]
    ds_read_b64_tr_b16 v[184:185], v19 offset:32768
    ds_read_b64_tr_b16 v[186:187], v19 offset:33280
    v_xor_b32 v8, s15, v7
    v_mfma_f32_32x32x16_bf16 v[144:159], v[192:195], v[76:79], v[144:159]
    ds_read_b64_tr_b16 v[188:189], v19 offset:34816
    ds_read_b64_tr_b16 v[190:191], v19 offset:35328
    s_bfe_u32 s15, s16, 0x10001
    s_waitcnt lgkmcnt(8)
    v_mfma_f32_32x32x16_bf16 v[144:159], v[196:199], v[80:83], v[144:159]
    ds_read_b64_tr_b16 v[192:193], v19 offset:36864
    ds_read_b64_tr_b16 v[194:195], v19 offset:37376
    s_mul_i32 s15, s15, 57344
    v_mfma_f32_32x32x16_bf16 v[144:159], v[200:203], v[84:87], v[144:159]
    ds_read_b64_tr_b16 v[196:197], v19 offset:38912
    ds_read_b64_tr_b16 v[198:199], v19 offset:39424
    s_barrier
    v_add_u32 v8, s15, v8
    s_waitcnt lgkmcnt(8)
    v_mfma_f32_32x32x16_bf16 v[144:159], v[176:179], v[88:91], v[144:159]
    ds_read_b64_tr_b16 v[200:201], v19 offset:40960
    ds_read_b64_tr_b16 v[202:203], v19 offset:41472
    s_lshl_b32 s15, s16, 7
    v_mfma_f32_32x32x16_bf16 v[144:159], v[180:183], v[92:95], v[144:159]
    ds_read_b64_tr_b16 v[176:177], v19 offset:43008
    ds_read_b64_tr_b16 v[178:179], v19 offset:43520
    v_add_u32 v27, s15, v29
    s_waitcnt lgkmcnt(8)
    v_mfma_f32_32x32x16_bf16 v[144:159], v[184:187], v[96:99], v[144:159]
    ds_read_b64_tr_b16 v[180:181], v19 offset:45056
    ds_read_b64_tr_b16 v[182:183], v19 offset:45568
    s_add_u32 s22, s22, 1
    v_mfma_f32_32x32x16_bf16 v[144:159], v[188:191], v[100:103], v[144:159]
    ds_read_b64_tr_b16 v[184:185], v19 offset:47104
    ds_read_b64_tr_b16 v[186:187], v19 offset:47616
    s_waitcnt lgkmcnt(8)
    v_mfma_f32_32x32x16_bf16 v[144:159], v[192:195], v[104:107], v[144:159]
    ds_read_b64_tr_b16 v[188:189], v19 offset:49152
    ds_read_b64_tr_b16 v[190:191], v19 offset:49664
    v_mfma_f32_32x32x16_bf16 v[144:159], v[196:199], v[108:111], v[144:159]
    ds_read_b64_tr_b16 v[192:193], v19 offset:51200
    ds_read_b64_tr_b16 v[194:195], v19 offset:51712
    s_waitcnt lgkmcnt(8)
    v_mfma_f32_32x32x16_bf16 v[144:159], v[200:203], v[112:115], v[144:159]
    ds_read_b64_tr_b16 v[196:197], v19 offset:53248
    ds_read_b64_tr_b16 v[198:199], v19 offset:53760
    v_mfma_f32_32x32x16_bf16 v[144:159], v[176:179], v[116:119], v[144:159]
    ds_read_b64_tr_b16 v[200:201], v19 offset:55296
    ds_read_b64_tr_b16 v[202:203], v19 offset:55808
    ds_read_b128 v[204:207], v27 offset:0
    ds_read_b128 v[208:211], v27 offset:32
    ds_read_b128 v[212:215], v27 offset:64
    ds_read_b128 v[216:219], v27 offset:96
    s_waitcnt lgkmcnt(12)
    v_mfma_f32_32x32x16_bf16 v[144:159], v[180:183], v[120:123], v[144:159]
    ds_read_b64_tr_b16 v[176:177], v8 offset:0
    ds_read_b64_tr_b16 v[178:179], v8 offset:512
    v_mfma_f32_32x32x16_bf16 v[144:159], v[184:187], v[124:127], v[144:159]
    ds_read_b64_tr_b16 v[180:181], v8 offset:2048
    ds_read_b64_tr_b16 v[182:183], v8 offset:2560
    s_waitcnt lgkmcnt(12)
    v_mfma_f32_32x32x16_bf16 v[144:159], v[188:191], v[128:131], v[144:159]
    ds_read_b64_tr_b16 v[184:185], v8 offset:4096
    ds_read_b64_tr_b16 v[186:187], v8 offset:4608
    v_mfma_f32_32x32x16_bf16 v[144:159], v[192:195], v[132:135], v[144:159]
    ds_read_b64_tr_b16 v[188:189], v8 offset:6144
    ds_read_b64_tr_b16 v[190:191], v8 offset:6656
    s_waitcnt lgkmcnt(12)
    v_mfma_f32_32x32x16_bf16 v[144:159], v[196:199], v[136:139], v[144:159]
    ds_read_b64_tr_b16 v[192:193], v8 offset:8192
    ds_read_b64_tr_b16 v[194:195], v8 offset:8704
    v_mfma_f32_32x32x16_bf16 v[160:175], v[200:203], v[140:143], v[144:159]
    ds_read_b64_tr_b16 v[196:197], v8 offset:10240
    ds_read_b64_tr_b16 v[198:199], v8 offset:10752
    s_cmp_lt_u32 s22, s19
    s_cbranch_scc1 C_DISP
    s_branch C_DONE_O
C_T:
    s_waitcnt lgkmcnt(8)
    v_mfma_f32_32x32x16_bf16 v[144:159], v[176:179], v[32:35], 0
    ds_read_b64_tr_b16 v[200:201], v8 offset:12288
    ds_read_b64_tr_b16 v[202:203], v8 offset:12800
    v_mfma_f32_32x32x16_bf16 v[144:159], v[180:183], v[36:39], v[144:159]
    ds_read_b64_tr_b16 v[176:177], v8 offset:14336
    ds_read_b64_tr_b16 v[178:179], v8 offset:14848
    s_cmp_eq_u32 s27, 0
    s_cbranch_scc1 NS3
    v_mul_f32 v160, s31, v160
    v_mul_f32 v161, s31, v161
    v_mul_f32 v162, s31, v162
    v_mul_f32 v163, s31, v163
    v_mul_f32 v164, s31, v164
    v_mul_f32 v165, s31, v165
    v_mul_f32 v166, s31, v166
    v_mul_f32 v167, s31, v167
    v_mul_f32 v168, s31, v168
    v_mul_f32 v169, s31, v169
    v_mul_f32 v170, s31, v170
    v_mul_f32 v171, s31, v171
    v_mul_f32 v172, s31, v172
    v_mul_f32 v173, s31, v173
    v_mul_f32 v174, s31, v174
    v_mul_f32 v175, s31, v175
NS3:
    v_cvt_pk_bf16_f32 v220, v160, v161
    v_cvt_pk_bf16_f32 v221, v162, v163
    v_cvt_pk_bf16_f32 v222, v164, v165
    v_cvt_pk_bf16_f32 v223, v166, v167
    s_waitcnt lgkmcnt(8)
    v_mfma_f32_32x32x16_bf16 v[144:159], v[184:187], v[40:43], v[144:159]
    ds_read_b64_tr_b16 v[180:181], v8 offset:16384
    ds_read_b64_tr_b16 v[182:183], v8 offset:16896
    v_cvt_pk_bf16_f32 v224, v168, v169
    v_cvt_pk_bf16_f32 v225, v170, v171
    v_cvt_pk_bf16_f32 v226, v172, v173
    v_cvt_pk_bf16_f32 v227, v174, v175
    v_mfma_f32_32x32x16_bf16 v[144:159], v[188:191], v[44:47], v[144:159]
    ds_read_b64_tr_b16 v[184:185], v8 offset:18432
    ds_read_b64_tr_b16 v[186:187], v8 offset:18944
    ds_write_b128 v6, v[220:223] offset:2048
    ds_write_b128 v6, v[224:227] offset:3072
    s_mov_b32 s27, s38
    s_waitcnt lgkmcnt(10)
    v_mfma_f32_32x32x16_bf16 v[144:159], v[192:195], v[48:51], v[144:159]
    ds_read_b64_tr_b16 v[188:189], v8 offset:20480
    ds_read_b64_tr_b16 v[190:191], v8 offset:20992
    v_mfma_f32_32x32x16_bf16 v[144:159], v[196:199], v[52:55], v[144:159]
    ds_read_b64_tr_b16 v[192:193], v8 offset:22528
    ds_read_b64_tr_b16 v[194:195], v8 offset:23040
    s_waitcnt lgkmcnt(10)
    v_mfma_f32_32x32x16_bf16 v[144:159], v[200:203], v[56:59], v[144:159]
    ds_read_b64_tr_b16 v[196:197], v8 offset:24576
    ds_read_b64_tr_b16 v[198:199], v8 offset:25088
    s_waitcnt lgkmcnt(6)
    s_barrier
    s_add_u32 s16, s22, 1
    s_and_b32 s24, s16, 1
    v_mfma_f32_32x32x16_bf16 v[144:159], v[176:179], v[60:63], v[144:159]
    ds_read_b64_tr_b16 v[200:201], v8 offset:26624
    ds_read_b64_tr_b16 v[202:203], v8 offset:27136
    s_and_b32 s17, s13, 1
    s_cmp_eq_u32 s16, 6
    s_waitcnt lgkmcnt(10)
    v_mfma_f32_32x32x16_bf16 v[144:159], v[180:183], v[64:67], v[144:159]
    ds_read_b64_tr_b16 v[176:177], v8 offset:28672
    ds_read_b64_tr_b16 v[178:179], v8 offset:29184
    s_cselect_b32 s24, s17, s24
    v_mfma_f32_32x32x16_bf16 v[144:159], v[184:187], v[68:71], v[144:159]
    ds_read_b64_tr_b16 v[180:181], v8 offset:30720
    ds_read_b64_tr_b16 v[182:183], v8 offset:31232
    s_lshl_b32 s15, s24, 6
    s_waitcnt lgkmcnt(8)
    v_mfma_f32_32x32x16_bf16 v[144:159], v[188:191], v[72:75], v[144:159]
    ds_read_b64_tr_b16 v[184:185], v8 offset:32768
    ds_read_b64_tr_b16 v[186:187], v8 offset:33280
    v_xor_b32 v19, s15, v7
    v_mfma_f32_32x32x16_bf16 v[144:159], v[192:195], v[76:79], v[144:159]
    ds_read_b64_tr_b16 v[188:189], v8 offset:34816
    ds_read_b64_tr_b16 v[190:191], v8 offset:35328
    s_bfe_u32 s15, s16, 0x10001
    s_waitcnt lgkmcnt(8)
    v_mfma_f32_32x32x16_bf16 v[144:159], v[196:199], v[80:83], v[144:159]
    ds_read_b64_tr_b16 v[192:193], v8 offset:36864
    ds_read_b64_tr_b16 v[194:195], v8 offset:37376
    s_mul_i32 s15, s15, 57344
    v_mfma_f32_32x32x16_bf16 v[144:159], v[200:203], v[84:87], v[144:159]
    ds_read_b64_tr_b16 v[196:197], v8 offset:38912
    ds_read_b64_tr_b16 v[198:199], v8 offset:39424
    v_add_u32 v19, s15, v19
    s_waitcnt lgkmcnt(8)
    v_mfma_f32_32x32x16_bf16 v[144:159], v[176:179], v[88:91], v[144:159]
    ds_read_b64_tr_b16 v[200:201], v8 offset:40960
    ds_read_b64_tr_b16 v[202:203], v8 offset:41472
    s_lshl_b32 s15, s16, 7
    v_mfma_f32_32x32x16_bf16 v[144:159], v[180:183], v[92:95], v[144:159]
    ds_read_b64_tr_b16 v[176:177], v8 offset:43008
    ds_read_b64_tr_b16 v[178:179], v8 offset:43520
    v_add_u32 v27, s15, v29
    s_waitcnt lgkmcnt(8)
    v_mfma_f32_32x32x16_bf16 v[144:159], v[184:187], v[96:99], v[144:159]
    ds_read_b64_tr_b16 v[180:181], v8 offset:45056
    ds_read_b64_tr_b16 v[182:183], v8 offset:45568
    s_add_u32 s22, s22, 1
    v_mfma_f32_32x32x16_bf16 v[144:159], v[188:191], v[100:103], v[144:159]
    ds_read_b64_tr_b16 v[184:185], v8 offset:47104
    ds_read_b64_tr_b16 v[186:187], v8 offset:47616
    s_waitcnt lgkmcnt(8)
    v_mfma_f32_32x32x16_bf16 v[144:159], v[192:195], v[104:107], v[144:159]
    ds_read_b64_tr_b16 v[188:189], v8 offset:49152
    ds_read_b64_tr_b16 v[190:191], v8 offset:49664
    v_mfma_f32_32x32x16_bf16 v[144:159], v[196:199], v[108:111], v[144:159]
    ds_read_b64_tr_b16 v[192:193], v8 offset:51200
    ds_read_b64_tr_b16 v[194:195], v8 offset:51712
    s_waitcnt lgkmcnt(8)
    v_mfma_f32_32x32x16_bf16 v[144:159], v[200:203], v[112:115], v[144:159]
    ds_read_b64_tr_b16 v[196:197], v8 offset:53248
    ds_read_b64_tr_b16 v[198:199], v8 offset:53760
    v_mfma_f32_32x32x16_bf16 v[144:159], v[176:179], v[116:119], v[144:159]
    ds_read_b64_tr_b16 v[200:201], v8 offset:55296
    ds_read_b64_tr_b16 v[202:203], v8 offset:55808
    ds_read_b128 v[204:207], v27 offset:0
    ds_read_b128 v[208:211], v27 offset:32
    ds_read_b128 v[212:215], v27 offset:64
    ds_read_b128 v[216:219], v27 offset:96
    s_waitcnt lgkmcnt(12)
    v_mfma_f32_32x32x16_bf16 v[144:159], v[180:183], v[120:123], v[144:159]
    ds_read_b64_tr_b16 v[176:177], v19 offset:0
    ds_read_b64_tr_b16 v[178:179], v19 offset:512
    v_mfma_f32_32x32x16_bf16 v[144:159], v[184:187], v[124:127], v[144:159]
    ds_read_b64_tr_b16 v[180:181], v19 offset:2048
    ds_read_b64_tr_b16 v[182:183], v19 offset:2560
    s_waitcnt lgkmcnt(12)
    v_mfma_f32_32x32x16_bf16 v[144:159], v[188:191], v[128:131], v[144:159]
    ds_read_b64_tr_b16 v[184:185], v19 offset:4096
    ds_read_b64_tr_b16 v[186:187], v19 offset:4608
    v_mfma_f32_32x32x16_bf16 v[144:159], v[192:195], v[132:135], v[144:159]
    ds_read_b64_tr_b16 v[188:189], v19 offset:6144
    ds_read_b64_tr_b16 v[190:191], v19 offset:6656
    s_waitcnt lgkmcnt(12)
    v_mfma_f32_32x32x16_bf16 v[144:159], v[196:199], v[136:139], v[144:159]
    ds_read_b64_tr_b16 v[192:193], v19 offset:8192
    ds_read_b64_tr_b16 v[194:195], v19 offset:8704
    v_mfma_f32_32x32x16_bf16 v[160:175], v[200:203], v[140:143], v[144:159]
    ds_read_b64_tr_b16 v[196:197], v19 offset:10240
    ds_read_b64_tr_b16 v[198:199], v19 offset:10752
    s_cmp_ge_u32 s22, s19
    s_cbranch_scc1 C_DONE_E
    s_waitcnt lgkmcnt(8)
    v_mfma_f32_32x32x16_bf16 v[144:159], v[176:179], v[32:35], 0
    ds_read_b64_tr_b16 v[200:201], v19 offset:12288
    ds_read_b64_tr_b16 v[202:203], v19 offset:12800
    v_mfma_f32_32x32x16_bf16 v[144:159], v[180:183], v[36:39], v[144:159]
    ds_read_b64_tr_b16 v[176:177], v19 offset:14336
    ds_read_b64_tr_b16 v[178:179], v19 offset:14848
    s_cmp_eq_u32 s27, 0
    s_cbranch_scc1 NS4
    v_mul_f32 v160, s31, v160
    v_mul_f32 v161, s31, v161
    v_mul_f32 v162, s31, v162
    v_mul_f32 v163, s31, v163
    v_mul_f32 v164, s31, v164
    v_mul_f32 v165, s31, v165
    v_mul_f32 v166, s31, v166
    v_mul_f32 v167, s31, v167
    v_mul_f32 v168, s31, v168
    v_mul_f32 v169, s31, v169
    v_mul_f32 v170, s31, v170
    v_mul_f32 v171, s31, v171
    v_mul_f32 v172, s31, v172
    v_mul_f32 v173, s31, v173
    v_mul_f32 v174, s31, v174
    v_mul_f32 v175, s31, v175
NS4:
    v_cvt_pk_bf16_f32 v220, v160, v161
    v_cvt_pk_bf16_f32 v221, v162, v163
    v_cvt_pk_bf16_f32 v222, v164, v165
    v_cvt_pk_bf16_f32 v223, v166, v167
    s_waitcnt lgkmcnt(8)
    v_mfma_f32_32x32x16_bf16 v[144:159], v[184:187], v[40:43], v[144:159]
    ds_read_b64_tr_b16 v[180:181], v19 offset:16384
    ds_read_b64_tr_b16 v[182:183], v19 offset:16896
    v_cvt_pk_bf16_f32 v224, v168, v169
    v_cvt_pk_bf16_f32 v225, v170, v171
    v_cvt_pk_bf16_f32 v226, v172, v173
    v_cvt_pk_bf16_f32 v227, v174, v175
    v_mfma_f32_32x32x16_bf16 v[144:159], v[188:191], v[44:47], v[144:159]
    ds_read_b64_tr_b16 v[184:185], v19 offset:18432
    ds_read_b64_tr_b16 v[186:187], v19 offset:18944
    ds_write_b128 v6, v[220:223] offset:0
    ds_write_b128 v6, v[224:227] offset:1024
    s_mov_b32 s27, s38
    s_waitcnt lgkmcnt(10)
    v_mfma_f32_32x32x16_bf16 v[144:159], v[192:195], v[48:51], v[144:159]
    ds_read_b64_tr_b16 v[188:189], v19 offset:20480
    ds_read_b64_tr_b16 v[190:191], v19 offset:20992
    v_mfma_f32_32x32x16_bf16 v[144:159], v[196:199], v[52:55], v[144:159]
    ds_read_b64_tr_b16 v[192:193], v19 offset:22528
    ds_read_b64_tr_b16 v[194:195], v19 offset:23040
    s_waitcnt lgkmcnt(10)
    v_mfma_f32_32x32x16_bf16 v[144:159], v[200:203], v[56:59], v[144:159]
    ds_read_b64_tr_b16 v[196:197], v19 offset:24576
    ds_read_b64_tr_b16 v[198:199], v19 offset:25088
    s_add_u32 s16, s22, 1
    s_and_b32 s24, s16, 1
    v_mfma_f32_32x32x16_bf16 v[144:159], v[176:179], v[60:63], v[144:159]
    ds_read_b64_tr_b16 v[200:201], v19 offset:26624
    ds_read_b64_tr_b16 v[202:203], v19 offset:27136
    s_and_b32 s17, s13, 1
    s_cmp_eq_u32 s16, 6
    s_waitcnt lgkmcnt(10)
    v_mfma_f32_32x32x16_bf16 v[144:159], v[180:183], v[64:67], v[144:159]
    ds_read_b64_tr_b16 v[176:177], v19 offset:28672
    ds_read_b64_tr_b16 v[178:179], v19 offset:29184
    s_cselect_b32 s24, s17, s24
    v_mfma_f32_32x32x16_bf16 v[144:159], v[184:187], v[68:71], v[144:159]
    ds_read_b64_tr_b16 v[180:181], v19 offset:30720
    ds_read_b64_tr_b16 v[182:183], v19 offset:31232
    s_lshl_b32 s15, s24, 6
    s_waitcnt lgkmcnt(8)
    v_mfma_f32_32x32x16_bf16 v[144:159], v[188:191], v[72:75], v[144:159]
    ds_read_b64_tr_b16 v[184:185], v19 offset:32768
    ds_read_b64_tr_b16 v[186:187], v19 offset:33280
    v_xor_b32 v8, s15, v7
    v_mfma_f32_32x32x16_bf16 v[144:159], v[192:195], v[76:79], v[144:159]
    ds_read_b64_tr_b16 v[188:189], v19 offset:34816
    ds_read_b64_tr_b16 v[190:191], v19 offset:35328
    s_bfe_u32 s15, s16, 0x10001
    s_waitcnt lgkmcnt(8)
    v_mfma_f32_32x32x16_bf16 v[144:159], v[196:199], v[80:83], v[144:159]
    ds_read_b64_tr_b16 v[192:193], v19 offset:36864
    ds_read_b64_tr_b16 v[194:195], v19 offset:37376
    s_mul_i32 s15, s15, 57344
    v_mfma_f32_32x32x16_bf16 v[144:159], v[200:203], v[84:87], v[144:159]
    ds_read_b64_tr_b16 v[196:197], v19 offset:38912
    ds_read_b64_tr_b16 v[198:199], v19 offset:39424
    s_barrier
    v_add_u32 v8, s15, v8
    s_waitcnt lgkmcnt(8)
    v_mfma_f32_32x32x16_bf16 v[144:159], v[176:179], v[88:91], v[144:159]
    ds_read_b64_tr_b16 v[200:201], v19 offset:40960
    ds_read_b64_tr_b16 v[202:203], v19 offset:41472
    s_lshl_b32 s15, s16, 7
    v_mfma_f32_32x32x16_bf16 v[144:159], v[180:183], v[92:95], v[144:159]
    ds_read_b64_tr_b16 v[176:177], v19 offset:43008
    ds_read_b64_tr_b16 v[178:179], v19 offset:43520
    v_add_u32 v27, s15, v29
    s_waitcnt lgkmcnt(8)
    v_mfma_f32_32x32x16_bf16 v[144:159], v[184:187], v[96:99], v[144:159]
    ds_read_b64_tr_b16 v[180:181], v19 offset:45056
    ds_read_b64_tr_b16 v[182:183], v19 offset:45568
    s_add_u32 s22, s22, 1
    v_mfma_f32_32x32x16_bf16 v[144:159], v[188:191], v[100:103], v[144:159]
    ds_read_b64_tr_b16 v[184:185], v19 offset:47104
    ds_read_b64_tr_b16 v[186:187], v19 offset:47616
    s_waitcnt lgkmcnt(8)
    v_mfma_f32_32x32x16_bf16 v[144:159], v[192:195], v[104:107], v[144:159]
    ds_read_b64_tr_b16 v[188:189], v19 offset:49152
    ds_read_b64_tr_b16 v[190:191], v19 offset:49664
    v_mfma_f32_32x32x16_bf16 v[144:159], v[196:199], v[108:111], v[144:159]
    ds_read_b64_tr_b16 v[192:193], v19 offset:51200
    ds_read_b64_tr_b16 v[194:195], v19 offset:51712
    s_waitcnt lgkmcnt(8)
    v_mfma_f32_32x32x16_bf16 v[144:159], v[200:203], v[112:115], v[144:159]
    ds_read_b64_tr_b16 v[196:197], v19 offset:53248
    ds_read_b64_tr_b16 v[198:199], v19 offset:53760
    v_mfma_f32_32x32x16_bf16 v[144:159], v[176:179], v[116:119], v[144:159]
    ds_read_b64_tr_b16 v[200:201], v19 offset:55296
    ds_read_b64_tr_b16 v[202:203], v19 offset:55808
    ds_read_b128 v[204:207], v27 offset:0
    ds_read_b128 v[208:211], v27 offset:32
    ds_read_b128 v[212:215], v27 offset:64
    ds_read_b128 v[216:219], v27 offset:96
    s_waitcnt lgkmcnt(12)
    v_mfma_f32_32x32x16_bf16 v[144:159], v[180:183], v[120:123], v[144:159]
    ds_read_b64_tr_b16 v[176:177], v8 offset:0
    ds_read_b64_tr_b16 v[178:179], v8 offset:512
    v_mfma_f32_32x32x16_bf16 v[144:159], v[184:187], v[124:127], v[144:159]
    ds_read_b64_tr_b16 v[180:181], v8 offset:2048
    ds_read_b64_tr_b16 v[182:183], v8 offset:2560
    s_waitcnt lgkmcnt(12)
    v_mfma_f32_32x32x16_bf16 v[144:159], v[188:191], v[128:131], v[144:159]
    ds_read_b64_tr_b16 v[184:185], v8 offset:4096
    ds_read_b64_tr_b16 v[186:187], v8 offset:4608
    v_mfma_f32_32x32x16_bf16 v[144:159], v[192:195], v[132:135], v[144:159]
    ds_read_b64_tr_b16 v[188:189], v8 offset:6144
    ds_read_b64_tr_b16 v[190:191], v8 offset:6656
    s_waitcnt lgkmcnt(12)
    v_mfma_f32_32x32x16_bf16 v[144:159], v[196:199], v[136:139], v[144:159]
    ds_read_b64_tr_b16 v[192:193], v8 offset:8192
    ds_read_b64_tr_b16 v[194:195], v8 offset:8704
    v_mfma_f32_32x32x16_bf16 v[160:175], v[200:203], v[140:143], v[144:159]
    ds_read_b64_tr_b16 v[196:197], v8 offset:10240
    ds_read_b64_tr_b16 v[198:199], v8 offset:10752
    s_cmp_lt_u32 s22, s19
    s_cbranch_scc1 C_DISP
    s_branch C_DONE_O
C_V:
    s_waitcnt lgkmcnt(8)
    v_mfma_f32_32x32x16_bf16 v[144:159], v[32:35], v[176:179], 0
    ds_read_b64_tr_b16 v[200:201], v8 offset:12288
    ds_read_b64_tr_b16 v[202:203], v8 offset:12800
    v_mfma_f32_32x32x16_bf16 v[144:159], v[36:39], v[180:183], v[144:159]
    ds_read_b64_tr_b16 v[176:177], v8 offset:14336
    ds_read_b64_tr_b16 v[178:179], v8 offset:14848
    s_cmp_eq_u32 s27, 0
    s_cbranch_scc1 NS5
    v_mul_f32 v160, s31, v160
    v_mul_f32 v161, s31, v161
    v_mul_f32 v162, s31, v162
    v_mul_f32 v163, s31, v163
    v_mul_f32 v164, s31, v164
    v_mul_f32 v165, s31, v165
    v_mul_f32 v166, s31, v166
    v_mul_f32 v167, s31, v167
    v_mul_f32 v168, s31, v168
    v_mul_f32 v169, s31, v169
    v_mul_f32 v170, s31, v170
    v_mul_f32 v171, s31, v171
    v_mul_f32 v172, s31, v172
    v_mul_f32 v173, s31, v173
    v_mul_f32 v174, s31, v174
    v_mul_f32 v175, s31, v175
NS5:
    v_cvt_pk_bf16_f32 v220, v160, v161
    v_cvt_pk_bf16_f32 v221, v162, v163
    v_cvt_pk_bf16_f32 v222, v164, v165
    v_cvt_pk_bf16_f32 v223, v166, v167
    s_waitcnt lgkmcnt(8)
    v_mfma_f32_32x32x16_bf16 v[144:159], v[40:43], v[184:187], v[144:159]
    ds_read_b64_tr_b16 v[180:181], v8 offset:16384
    ds_read_b64_tr_b16 v[182:183], v8 offset:16896
    v_cvt_pk_bf16_f32 v224, v168, v169
    v_cvt_pk_bf16_f32 v225, v170, v171
    v_cvt_pk_bf16_f32 v226, v172, v173
    v_cvt_pk_bf16_f32 v227, v174, v175
    v_mfma_f32_32x32x16_bf16 v[144:159], v[44:47], v[188:191], v[144:159]
    ds_read_b64_tr_b16 v[184:185], v8 offset:18432
    ds_read_b64_tr_b16 v[186:187], v8 offset:18944
    ds_write_b128 v6, v[220:223] offset:2048
    ds_write_b128 v6, v[224:227] offset:3072
    s_mov_b32 s27, s38
    s_waitcnt lgkmcnt(10)
    v_mfma_f32_32x32x16_bf16 v[144:159], v[48:51], v[192:195], v[144:159]
    ds_read_b64_tr_b16 v[188:189], v8 offset:20480
    ds_read_b64_tr_b16 v[190:191], v8 offset:20992
    v_mfma_f32_32x32x16_bf16 v[144:159], v[52:55], v[196:199], v[144:159]
    ds_read_b64_tr_b16 v[192:193], v8 offset:22528
    ds_read_b64_tr_b16 v[194:195], v8 offset:23040
    s_waitcnt lgkmcnt(10)
    v_mfma_f32_32x32x16_bf16 v[144:159], v[56:59], v[200:203], v[144:159]
    ds_read_b64_tr_b16 v[196:197], v8 offset:24576
    ds_read_b64_tr_b16 v[198:199], v8 offset:25088
    s_waitcnt lgkmcnt(6)
    s_barrier
    s_add_u32 s16, s22, 1
    s_and_b32 s24, s16, 1
    v_mfma_f32_32x32x16_bf16 v[144:159], v[60:63], v[176:179], v[144:159]
    ds_read_b64_tr_b16 v[200:201], v8 offset:26624
    ds_read_b64_tr_b16 v[202:203], v8 offset:27136
    s_and_b32 s17, s13, 1
    s_cmp_eq_u32 s16, 6
    s_waitcnt lgkmcnt(10)
    v_mfma_f32_32x32x16_bf16 v[144:159], v[64:67], v[180:183], v[144:159]
    ds_read_b64_tr_b16 v[176:177], v8 offset:28672
    ds_read_b64_tr_b16 v[178:179], v8 offset:29184
    s_cselect_b32 s24, s17, s24
    v_mfma_f32_32x32x16_bf16 v[144:159], v[68:71], v[184:187], v[144:159]
    ds_read_b64_tr_b16 v[180:181], v8 offset:30720
    ds_read_b64_tr_b16 v[182:183], v8 offset:31232
    s_lshl_b32 s15, s24, 6
    s_waitcnt lgkmcnt(8)
    v_mfma_f32_32x32x16_bf16 v[144:159], v[72:75], v[188:191], v[144:159]
    ds_read_b64_tr_b16 v[184:185], v8 offset:32768
    ds_read_b64_tr_b16 v[186:187], v8 offset:33280
    v_xor_b32 v19, s15, v7
    v_mfma_f32_32x32x16_bf16 v[144:159], v[76:79], v[192:195], v[144:159]
    ds_read_b64_tr_b16 v[188:189], v8 offset:34816
    ds_read_b64_tr_b16 v[190:191], v8 offset:35328
    s_bfe_u32 s15, s16, 0x10001
    s_waitcnt lgkmcnt(8)
    v_mfma_f32_32x32x16_bf16 v[144:159], v[80:83], v[196:199], v[144:159]
    ds_read_b64_tr_b16 v[192:193], v8 offset:36864
    ds_read_b64_tr_b16 v[194:195], v8 offset:37376
    s_mul_i32 s15, s15, 57344
    v_mfma_f32_32x32x16_bf16 v[144:159], v[84:87], v[200:203], v[144:159]
    ds_read_b64_tr_b16 v[196:197], v8 offset:38912
    ds_read_b64_tr_b16 v[198:199], v8 offset:39424
    v_add_u32 v19, s15, v19
    s_waitcnt lgkmcnt(8)
    v_mfma_f32_32x32x16_bf16 v[144:159], v[88:91], v[176:179], v[144:159]
    ds_read_b64_tr_b16 v[200:201], v8 offset:40960
    ds_read_b64_tr_b16 v[202:203], v8 offset:41472
    s_lshl_b32 s15, s16, 7
    v_mfma_f32_32x32x16_bf16 v[144:159], v[92:95], v[180:183], v[144:159]
    ds_read_b64_tr_b16 v[176:177], v8 offset:43008
    ds_read_b64_tr_b16 v[178:179], v8 offset:43520
    v_add_u32 v27, s15, v29
    s_waitcnt lgkmcnt(8)
    v_mfma_f32_32x32x16_bf16 v[144:159], v[96:99], v[184:187], v[144:159]
    ds_read_b64_tr_b16 v[180:181], v8 offset:45056
    ds_read_b64_tr_b16 v[182:183], v8 offset:45568
    s_add_u32 s22, s22, 1
    v_mfma_f32_32x32x16_bf16 v[144:159], v[100:103], v[188:191], v[144:159]
    ds_read_b64_tr_b16 v[184:185], v8 offset:47104
    ds_read_b64_tr_b16 v[186:187], v8 offset:47616
    s_waitcnt lgkmcnt(8)
    v_mfma_f32_32x32x16_bf16 v[144:159], v[104:107], v[192:195], v[144:159]
    ds_read_b64_tr_b16 v[188:189], v8 offset:49152
    ds_read_b64_tr_b16 v[190:191], v8 offset:49664
    v_mfma_f32_32x32x16_bf16 v[144:159], v[108:111], v[196:199], v[144:159]
    ds_read_b64_tr_b16 v[192:193], v8 offset:51200
    ds_read_b64_tr_b16 v[194:195], v8 offset:51712
    s_waitcnt lgkmcnt(8)
    v_mfma_f32_32x32x16_bf16 v[144:159], v[112:115], v[200:203], v[144:159]
    ds_read_b64_tr_b16 v[196:197], v8 offset:53248
    ds_read_b64_tr_b16 v[198:199], v8 offset:53760
    v_mfma_f32_32x32x16_bf16 v[144:159], v[116:119], v[176:179], v[144:159]
    ds_read_b64_tr_b16 v[200:201], v8 offset:55296
    ds_read_b64_tr_b16 v[202:203], v8 offset:55808
    ds_read_b128 v[204:207], v27 offset:0
    ds_read_b128 v[208:211], v27 offset:32
    ds_read_b128 v[212:215], v27 offset:64
    ds_read_b128 v[216:219], v27 offset:96
    s_waitcnt lgkmcnt(12)
    v_mfma_f32_32x32x16_bf16 v[144:159], v[120:123], v[180:183], v[144:159]
    ds_read_b64_tr_b16 v[176:177], v19 offset:0
    ds_read_b64_tr_b16 v[178:179], v19 offset:512
    v_mfma_f32_32x32x16_bf16 v[144:159], v[124:127], v[184:187], v[144:159]
    ds_read_b64_tr_b16 v[180:181], v19 offset:2048
    ds_read_b64_tr_b16 v[182:183], v19 offset:2560
    s_waitcnt lgkmcnt(12)
    v_mfma_f32_32x32x16_bf16 v[144:159], v[128:131], v[188:191], v[144:159]
    ds_read_b64_tr_b16 v[184:185], v19 offset:4096
    ds_read_b64_tr_b16 v[186:187], v19 offset:4608
    v_mfma_f32_32x32x16_bf16 v[144:159], v[132:135], v[192:195], v[144:159]
    ds_read_b64_tr_b16 v[188:189], v19 offset:6144
    ds_read_b64_tr_b16 v[190:191], v19 offset:6656
    s_waitcnt lgkmcnt(12)
    v_mfma_f32_32x32x16_bf16 v[144:159], v[136:139], v[196:199], v[144:159]
    ds_read_b64_tr_b16 v[192:193], v19 offset:8192
    ds_read_b64_tr_b16 v[194:195], v19 offset:8704
    v_mfma_f32_32x32x16_bf16 v[160:175], v[140:143], v[200:203], v[144:159]
    ds_read_b64_tr_b16 v[196:197], v19 offset:10240
    ds_read_b64_tr_b16 v[198:199], v19 offset:10752
    s_cmp_ge_u32 s22, s19
    s_cbranch_scc1 C_DONE_E
    s_waitcnt lgkmcnt(8)
    v_mfma_f32_32x32x16_bf16 v[144:159], v[32:35], v[176:179], 0
    ds_read_b64_tr_b16 v[200:201], v19 offset:12288
    ds_read_b64_tr_b16 v[202:203], v19 offset:12800
    v_mfma_f32_32x32x16_bf16 v[144:159], v[36:39], v[180:183], v[144:159]
    ds_read_b64_tr_b16 v[176:177], v19 offset:14336
    ds_read_b64_tr_b16 v[178:179], v19 offset:14848
    s_cmp_eq_u32 s27, 0
    s_cbranch_scc1 NS6
    v_mul_f32 v160, s31, v160
    v_mul_f32 v161, s31, v161
    v_mul_f32 v162, s31, v162
    v_mul_f32 v163, s31, v163
    v_mul_f32 v164, s31, v164
    v_mul_f32 v165, s31, v165
    v_mul_f32 v166, s31, v166
    v_mul_f32 v167, s31, v167
    v_mul_f32 v168, s31, v168
    v_mul_f32 v169, s31, v169
    v_mul_f32 v170, s31, v170
    v_mul_f32 v171, s31, v171
    v_mul_f32 v172, s31, v172
    v_mul_f32 v173, s31, v173
    v_mul_f32 v174, s31, v174
    v_mul_f32 v175, s31, v175
NS6:
    v_cvt_pk_bf16_f32 v220, v160, v161
    v_cvt_pk_bf16_f32 v221, v162, v163
    v_cvt_pk_bf16_f32 v222, v164, v165
    v_cvt_pk_bf16_f32 v223, v166, v167
    s_waitcnt lgkmcnt(8)
    v_mfma_f32_32x32x16_bf16 v[144:159], v[40:43], v[184:187], v[144:159]
    ds_read_b64_tr_b16 v[180:181], v19 offset:16384
    ds_read_b64_tr_b16 v[182:183], v19 offset:16896
    v_cvt_pk_bf16_f32 v224, v168, v169
    v_cvt_pk_bf16_f32 v225, v170, v171
    v_cvt_pk_bf16_f32 v226, v172, v173
    v_cvt_pk_bf16_f32 v227, v174, v175
    v_mfma_f32_32x32x16_bf16 v[144:159], v[44:47], v[188:191], v[144:159]
    ds_read_b64_tr_b16 v[184:185], v19 offset:18432
    ds_read_b64_tr_b16 v[186:187], v19 offset:18944
    ds_write_b128 v6, v[220:223] offset:0
    ds_write_b128 v6, v[224:227] offset:1024
    s_mov_b32 s27, s38
    s_waitcnt lgkmcnt(10)
    v_mfma_f32_32x32x16_bf16 v[144:159], v[48:51], v[192:195], v[144:159]
    ds_read_b64_tr_b16 v[188:189], v19 offset:20480
    ds_read_b64_tr_b16 v[190:191], v19 offset:20992
    v_mfma_f32_32x32x16_bf16 v[144:159], v[52:55], v[196:199], v[144:159]
    ds_read_b64_tr_b16 v[192:193], v19 offset:22528
    ds_read_b64_tr_b16 v[194:195], v19 offset:23040
    s_waitcnt lgkmcnt(10)
    v_mfma_f32_32x32x16_bf16 v[144:159], v[56:59], v[200:203], v[144:159]
    ds_read_b64_tr_b16 v[196:197], v19 offset:24576
    ds_read_b64_tr_b16 v[198:199], v19 offset:25088
    s_add_u32 s16, s22, 1
    s_and_b32 s24, s16, 1
    v_mfma_f32_32x32x16_bf16 v[144:159], v[60:63], v[176:179], v[144:159]
    ds_read_b64_tr_b16 v[200:201], v19 offset:26624
    ds_read_b64_tr_b16 v[202:203], v19 offset:27136
    s_and_b32 s17, s13, 1
    s_cmp_eq_u32 s16, 6
    s_waitcnt lgkmcnt(10)
    v_mfma_f32_32x32x16_bf16 v[144:159], v[64:67], v[180:183], v[144:159]
    ds_read_b64_tr_b16 v[176:177], v19 offset:28672
    ds_read_b64_tr_b16 v[178:179], v19 offset:29184
    s_cselect_b32 s24, s17, s24
    v_mfma_f32_32x32x16_bf16 v[144:159], v[68:71], v[184:187], v[144:159]
    ds_read_b64_tr_b16 v[180:181], v19 offset:30720
    ds_read_b64_tr_b16 v[182:183], v19 offset:31232
    s_lshl_b32 s15, s24, 6
    s_waitcnt lgkmcnt(8)
    v_mfma_f32_32x32x16_bf16 v[144:159], v[72:75], v[188:191], v[144:159]
    ds_read_b64_tr_b16 v[184:185], v19 offset:32768
    ds_read_b64_tr_b16 v[186:187], v19 offset:33280
    v_xor_b32 v8, s15, v7
    v_mfma_f32_32x32x16_bf16 v[144:159], v[76:79], v[192:195], v[144:159]
    ds_read_b64_tr_b16 v[188:189], v19 offset:34816
    ds_read_b64_tr_b16 v[190:191], v19 offset:35328
    s_bfe_u32 s15, s16, 0x10001
    s_waitcnt lgkmcnt(8)
    v_mfma_f32_32x32x16_bf16 v[144:159], v[80:83], v[196:199], v[144:159]
    ds_read_b64_tr_b16 v[192:193], v19 offset:36864
    ds_read_b64_tr_b16 v[194:195], v19 offset:37376
    s_mul_i32 s15, s15, 57344
    v_mfma_f32_32x32x16_bf16 v[144:159], v[84:87], v[200:203], v[144:159]
    ds_read_b64_tr_b16 v[196:197], v19 offset:38912
    ds_read_b64_tr_b16 v[198:199], v19 offset:39424
    s_barrier
    v_add_u32 v8, s15, v8
    s_waitcnt lgkmcnt(8)
    v_mfma_f32_32x32x16_bf16 v[144:159], v[88:91], v[176:179], v[144:159]
    ds_read_b64_tr_b16 v[200:201], v19 offset:40960
    ds_read_b64_tr_b16 v[202:203], v19 offset:41472
    s_lshl_b32 s15, s16, 7
    v_mfma_f32_32x32x16_bf16 v[144:159], v[92:95], v[180:183], v[144:159]
    ds_read_b64_tr_b16 v[176:177], v19 offset:43008
    ds_read_b64_tr_b16 v[178:179], v19 offset:43520
    v_add_u32 v27, s15, v29
    s_waitcnt lgkmcnt(8)
    v_mfma_f32_32x32x16_bf16 v[144:159], v[96:99], v[184:187], v[144:159]
    ds_read_b64_tr_b16 v[180:181], v19 offset:45056
    ds_read_b64_tr_b16 v[182:183], v19 offset:45568
    s_add_u32 s22, s22, 1
    v_mfma_f32_32x32x16_bf16 v[144:159], v[100:103], v[188:191], v[144:159]
    ds_read_b64_tr_b16 v[184:185], v19 offset:47104
    ds_read_b64_tr_b16 v[186:187], v19 offset:47616
    s_waitcnt lgkmcnt(8)
    v_mfma_f32_32x32x16_bf16 v[144:159], v[104:107], v[192:195], v[144:159]
    ds_read_b64_tr_b16 v[188:189], v19 offset:49152
    ds_read_b64_tr_b16 v[190:191], v19 offset:49664
    v_mfma_f32_32x32x16_bf16 v[144:159], v[108:111], v[196:199], v[144:159]
    ds_read_b64_tr_b16 v[192:193], v19 offset:51200
    ds_read_b64_tr_b16 v[194:195], v19 offset:51712
    s_waitcnt lgkmcnt(8)
    v_mfma_f32_32x32x16_bf16 v[144:159], v[112:115], v[200:203], v[144:159]
    ds_read_b64_tr_b16 v[196:197], v19 offset:53248
    ds_read_b64_tr_b16 v[198:199], v19 offset:53760
    v_mfma_f32_32x32x16_bf16 v[144:159], v[116:119], v[176:179], v[144:159]
    ds_read_b64_tr_b16 v[200:201], v19 offset:55296
    ds_read_b64_tr_b16 v[202:203], v19 offset:55808
    ds_read_b128 v[204:207], v27 offset:0
    ds_read_b128 v[208:211], v27 offset:32
    ds_read_b128 v[212:215], v27 offset:64
    ds_read_b128 v[216:219], v27 offset:96
    s_waitcnt lgkmcnt(12)
    v_mfma_f32_32x32x16_bf16 v[144:159], v[120:123], v[180:183], v[144:159]
    ds_read_b64_tr_b16 v[176:177], v8 offset:0
    ds_read_b64_tr_b16 v[178:179], v8 offset:512
    v_mfma_f32_32x32x16_bf16 v[144:159], v[124:127], v[184:187], v[144:159]
    ds_read_b64_tr_b16 v[180:181], v8 offset:2048
    ds_read_b64_tr_b16 v[182:183], v8 offset:2560
    s_waitcnt lgkmcnt(12)
    v_mfma_f32_32x32x16_bf16 v[144:159], v[128:131], v[188:191], v[144:159]
    ds_read_b64_tr_b16 v[184:185], v8 offset:4096
    ds_read_b64_tr_b16 v[186:187], v8 offset:4608
    v_mfma_f32_32x32x16_bf16 v[144:159], v[132:135], v[192:195], v[144:159]
    ds_read_b64_tr_b16 v[188:189], v8 offset:6144
    ds_read_b64_tr_b16 v[190:191], v8 offset:6656
    s_waitcnt lgkmcnt(12)
    v_mfma_f32_32x32x16_bf16 v[144:159], v[136:139], v[196:199], v[144:159]
    ds_read_b64_tr_b16 v[192:193], v8 offset:8192
    ds_read_b64_tr_b16 v[194:195], v8 offset:8704
    v_mfma_f32_32x32x16_bf16 v[160:175], v[140:143], v[200:203], v[144:159]
    ds_read_b64_tr_b16 v[196:197], v8 offset:10240
    ds_read_b64_tr_b16 v[198:199], v8 offset:10752
    s_cmp_lt_u32 s22, s19
    s_cbranch_scc1 C_DISP
    s_branch C_DONE_O
C_DONE_E:
    s_cmp_eq_u32 s27, 0
    s_cbranch_scc1 NS7
    s_nop 5
    v_mul_f32 v160, s31, v160
    v_mul_f32 v161, s31, v161
    v_mul_f32 v162, s31, v162
    v_mul_f32 v163, s31, v163
    v_mul_f32 v164, s31, v164
    v_mul_f32 v165, s31, v165
    v_mul_f32 v166, s31, v166
    v_mul_f32 v167, s31, v167
    v_mul_f32 v168, s31, v168
    v_mul_f32 v169, s31, v169
    v_mul_f32 v170, s31, v170
    v_mul_f32 v171, s31, v171
    v_mul_f32 v172, s31, v172
    v_mul_f32 v173, s31, v173
    v_mul_f32 v174, s31, v174
    v_mul_f32 v175, s31, v175
NS7:
    s_nop 5
    v_cvt_pk_bf16_f32 v220, v160, v161
    v_cvt_pk_bf16_f32 v221, v162, v163
    v_cvt_pk_bf16_f32 v222, v164, v165
    v_cvt_pk_bf16_f32 v223, v166, v167
    v_cvt_pk_bf16_f32 v224, v168, v169
    v_cvt_pk_bf16_f32 v225, v170, v171
    v_cvt_pk_bf16_f32 v226, v172, v173
    v_cvt_pk_bf16_f32 v227, v174, v175
    ds_write_b128 v6, v[220:223] offset:0
    ds_write_b128 v6, v[224:227] offset:1024
    s_branch C_END
C_DONE_O:
    s_cmp_eq_u32 s27, 0
    s_cbranch_scc1 NS8
    s_nop 4
    v_mul_f32 v160, s31, v160
    v_mul_f32 v161, s31, v161
    v_mul_f32 v162, s31, v162
    v_mul_f32 v163, s31, v163
    v_mul_f32 v164, s31, v164
    v_mul_f32 v165, s31, v165
    v_mul_f32 v166, s31, v166
    v_mul_f32 v167, s31, v167
    v_mul_f32 v168, s31, v168
    v_mul_f32 v169, s31, v169
    v_mul_f32 v170, s31, v170
    v_mul_f32 v171, s31, v171
    v_mul_f32 v172, s31, v172
    v_mul_f32 v173, s31, v173
    v_mul_f32 v174, s31, v174
    v_mul_f32 v175, s31, v175
NS8:
    s_nop 4
    v_cvt_pk_bf16_f32 v220, v160, v161
    v_cvt_pk_bf16_f32 v221, v162, v163
    v_cvt_pk_bf16_f32 v222, v164, v165
    v_cvt_pk_bf16_f32 v223, v166, v167
    v_cvt_pk_bf16_f32 v224, v168, v169
    v_cvt_pk_bf16_f32 v225, v170, v171
    v_cvt_pk_bf16_f32 v226, v172, v173
    v_cvt_pk_bf16_f32 v227, v174, v175
    ds_write_b128 v6, v[220:223] offset:2048
    ds_write_b128 v6, v[224:227] offset:3072
C_END:
    s_mov_b32 s63, 19922944
    buffer_load_dword v30, v26, s[8:11], s63 offen sc0 sc1
    s_lshl_b32 s15, s12, 2
    s_add_u32 s15, s15, 157840
    v_mov_b32 v3, s15
    v_mov_b32 v4, 1
    s_waitcnt lgkmcnt(0)
    ds_write_b32 v3, v4
    v_mov_b32 v3, 157780
    ds_read_b32 v4, v3
    s_waitcnt lgkmcnt(0)
    v_readfirstlane_b32 s94, v4
    s_and_b32 s17, s2, 7
    s_lshr_b32 s19, s2, 3
    s_lshl_b32 s13, s17, 1
    s_and_b32 s17, s19, 1
    s_add_u32 s13, s13, s17
    s_lshr_b32 s14, s19, 1
    s_mov_b32 s20, 0
    s_mov_b32 s21, -1
    s_bitcmp1_b32 s13, 0
    s_mov_b32 s22, 0
    s_cselect_b32 s23, 0, -1
    s_cselect_b32 s24, -1, 0
    s_mov_b32 s25, 0
    v_add_u32 v3, 2097152, v2
    v_add_u32 v4, 4194304, v2
    s_lshl_b32 s17, s13, 6
    s_lshl_b32 s19, s14, 2
    s_add_u32 s17, s17, s19
    s_lshl_b32 s15, s17, 11
    s_lshl_b32 s17, s13, 6
    s_lshl_b32 s19, s12, 4
    s_add_u32 s17, s17, s19
    s_lshl_b32 s16, s17, 11
    s_mov_b32 s37, s16
    s_mov_b32 s36, 0
    v_mov_b32 v20, 0
    v_mov_b32 v21, 1
    v_mov_b32 v22, 157696
    s_mov_b32 s28, 0x0fffffff
    s_mov_b32 s29, 0x0fffffff
    s_mov_b32 s30, 0x10000000
    s_mov_b32 s31, 0x10000000
    v_mov_b32 v17, 0x3f803f80
    v_cndmask_b32 v17, 0, v17, s[30:31]
    v_mov_b32 v176, v17
    v_mov_b32 v177, v17
    v_mov_b32 v178, v17
    v_mov_b32 v179, v17
    v_mov_b32 v180, v17
    v_mov_b32 v181, v17
    v_mov_b32 v182, v17
    v_mov_b32 v183, v17
    v_mov_b32 v192, v17
    v_mov_b32 v193, v17
    v_mov_b32 v194, v17
    v_mov_b32 v195, v17
    v_mov_b32 v196, v17
    v_mov_b32 v197, v17
    v_mov_b32 v198, v17
    v_mov_b32 v199, v17
    v_mov_b32 v208, v17
    v_mov_b32 v209, v17
    v_mov_b32 v210, v17
    v_mov_b32 v211, v17
    v_mov_b32 v212, v17
    v_mov_b32 v213, v17
    v_mov_b32 v214, v17
    v_mov_b32 v215, v17
    v_mov_b32 v224, v17
    v_mov_b32 v225, v17
    v_mov_b32 v226, v17
    v_mov_b32 v227, v17
    v_mov_b32 v228, v17
    v_mov_b32 v229, v17
    v_mov_b32 v230, v17
    v_mov_b32 v231, v17
    v_mov_b32 v160, 0
    v_mov_b32 v161, 0
    v_mov_b32 v162, 0
    v_mov_b32 v163, 0
    v_mov_b32 v164, 0
    v_mov_b32 v165, 0
    v_mov_b32 v166, 0
    v_mov_b32 v167, 0
    s_waitcnt vmcnt(0)
    v_cmp_ne_u32 vcc, s94, v30
    s_nop 4
    s_cbranch_vccz AT_OK
    s_mov_b32 s61, 0
    s_mov_b32 s63, 19922944
    s_branch GP_AT_1
GP_AT:
    s_sleep 2
GP_AT_1:
    buffer_load_dword v6, v26, s[8:11], s63 offen sc0 sc1
    s_waitcnt vmcnt(0)
    v_cmp_ne_u32 vcc, s94, v6
    s_add_u32 s61, s61, 1
    s_cmp_gt_u32 s61, 0x20000
    s_cbranch_scc1 GP_AT_X
    s_cbranch_vccnz GP_AT
GP_AT_X:
AT_OK:
    s_setprio 1
    buffer_load_dwordx4 v[168:171], v3, s[8:11], s16 offen sc0 sc1
    buffer_load_dwordx4 v[172:175], v3, s[8:11], s16 offen offset:1024 sc0 sc1
    s_add_u32 s17, s12, 0
    s_and_b32 s17, s17, 3
    s_lshl_b32 s17, s17, 11
    s_add_u32 s17, s17, s15
    buffer_load_dwordx4 v[32:35], v2, s[8:11], s17 offen sc0 sc1
    buffer_load_dwordx4 v[36:39], v2, s[8:11], s17 offen offset:1024 sc0 sc1
    s_add_u32 s17, s12, 1
    s_and_b32 s17, s17, 3
    s_lshl_b32 s17, s17, 11
    s_add_u32 s17, s17, s15
    buffer_load_dwordx4 v[40:43], v2, s[8:11], s17 offen sc0 sc1
    buffer_load_dwordx4 v[44:47], v2, s[8:11], s17 offen offset:1024 sc0 sc1
    s_add_u32 s17, s12, 2
    s_and_b32 s17, s17, 3
    s_lshl_b32 s17, s17, 11
    s_add_u32 s17, s17, s15
    buffer_load_dwordx4 v[48:51], v2, s[8:11], s17 offen sc0 sc1
    buffer_load_dwordx4 v[52:55], v2, s[8:11], s17 offen offset:1024 sc0 sc1
    s_add_u32 s17, s12, 3
    s_and_b32 s17, s17, 3
    s_lshl_b32 s17, s17, 11
    s_add_u32 s17, s17, s15
    buffer_load_dwordx4 v[56:59], v2, s[8:11], s17 offen sc0 sc1
    buffer_load_dwordx4 v[60:63], v2, s[8:11], s17 offen offset:1024 sc0 sc1
    s_mov_b64 exec, s[28:29]
    buffer_load_dwordx4 v[176:179], v4, s[8:11], s16 offen sc0 sc1
    buffer_load_dwordx4 v[180:183], v4, s[8:11], s16 offen offset:1024 sc0 sc1
    s_mov_b64 exec, -1
    s_add_u32 s16, s16, 2048
    buffer_load_dwordx4 v[184:187], v3, s[8:11], s16 offen sc0 sc1
    buffer_load_dwordx4 v[188:191], v3, s[8:11], s16 offen offset:1024 sc0 sc1
    s_mov_b64 exec, s[28:29]
    buffer_load_dwordx4 v[192:195], v4, s[8:11], s16 offen sc0 sc1
    buffer_load_dwordx4 v[196:199], v4, s[8:11], s16 offen offset:1024 sc0 sc1
    s_mov_b64 exec, -1
    s_add_u32 s16, s16, 2048
    buffer_load_dwordx4 v[200:203], v3, s[8:11], s16 offen sc0 sc1
    buffer_load_dwordx4 v[204:207], v3, s[8:11], s16 offen offset:1024 sc0 sc1
    s_mov_b64 exec, s[28:29]
    buffer_load_dwordx4 v[208:211], v4, s[8:11], s16 offen sc0 sc1
    buffer_load_dwordx4 v[212:215], v4, s[8:11], s16 offen offset:1024 sc0 sc1
    s_mov_b64 exec, -1
    s_add_u32 s16, s16, 2048
    v_mov_b32 v64, 0
    v_mov_b32 v65, 0
    v_mov_b32 v66, 0
    v_mov_b32 v67, 0
    v_mov_b32 v68, 0
    v_mov_b32 v69, 0
    v_mov_b32 v70, 0
    v_mov_b32 v71, 0
    v_mov_b32 v72, 0
    v_mov_b32 v73, 0
    v_mov_b32 v74, 0
    v_mov_b32 v75, 0
    v_mov_b32 v76, 0
    v_mov_b32 v77, 0
    v_mov_b32 v78, 0
    v_mov_b32 v79, 0
    v_mov_b32 v80, 0
    v_mov_b32 v81, 0
    v_mov_b32 v82, 0
    v_mov_b32 v83, 0
    v_mov_b32 v84, 0
    v_mov_b32 v85, 0
    v_mov_b32 v86, 0
    v_mov_b32 v87, 0
    v_mov_b32 v88, 0
    v_mov_b32 v89, 0
    v_mov_b32 v90, 0
    v_mov_b32 v91, 0
    v_mov_b32 v92, 0
    v_mov_b32 v93, 0
    v_mov_b32 v94, 0
    v_mov_b32 v95, 0
    v_mov_b32 v96, 0
    v_mov_b32 v97, 0
    v_mov_b32 v98, 0
    v_mov_b32 v99, 0
    v_mov_b32 v100, 0
    v_mov_b32 v101, 0
    v_mov_b32 v102, 0
    v_mov_b32 v103, 0
    v_mov_b32 v104, 0
    v_mov_b32 v105, 0
    v_mov_b32 v106, 0
    v_mov_b32 v107, 0
    v_mov_b32 v108, 0
    v_mov_b32 v109, 0
    v_mov_b32 v110, 0
    v_mov_b32 v111, 0
    v_mov_b32 v112, 0
    v_mov_b32 v113, 0
    v_mov_b32 v114, 0
    v_mov_b32 v115, 0
    v_mov_b32 v116, 0
    v_mov_b32 v117, 0
    v_mov_b32 v118, 0
    v_mov_b32 v119, 0
    v_mov_b32 v120, 0
    v_mov_b32 v121, 0
    v_mov_b32 v122, 0
    v_mov_b32 v123, 0
    v_mov_b32 v124, 0
    v_mov_b32 v125, 0
    v_mov_b32 v126, 0
    v_mov_b32 v127, 0
    s_mov_b32 s62, 0
    s_branch LW1_1
LW1:
    s_sleep 1
LW1_1:
    s_add_u32 s62, s62, 1
    s_cmp_gt_u32 s62, 0x40000
    s_cbranch_scc1 LW1_X
    ds_read_b128 v[24:27], v22 offset:144
    s_waitcnt lgkmcnt(0)
    v_and_b32 v24, v24, v25
    v_and_b32 v26, v26, v27
    v_and_b32 v24, v24, v26
    s_nop 0
    v_readfirstlane_b32 s17, v24
    s_nop 0
    s_cmp_eq_u32 s17, 1
    s_cbranch_scc0 LW1
LW1_X:
    s_waitcnt vmcnt(16)
    v_cndmask_b32 v38, v38, 0, s[22:23]
    v_cndmask_b32 v39, v39, 0, s[22:23]
    v_cndmask_b32 v32, v32, 0, s[24:25]
    v_cndmask_b32 v33, v33, 0, s[24:25]
    s_nop 1
    v_mfma_f32_32x32x16_bf16 v[232:247], v[168:171], v[32:35], 0
    v_mfma_f32_32x32x16_bf16 v[232:247], v[172:175], v[36:39], v[232:247]
    s_waitcnt vmcnt(14)
    v_cndmask_b32 v46, v46, 0, s[22:23]
    v_cndmask_b32 v47, v47, 0, s[22:23]
    v_cndmask_b32 v40, v40, 0, s[24:25]
    v_cndmask_b32 v41, v41, 0, s[24:25]
    s_nop 1
    v_mfma_f32_32x32x16_bf16 v[144:159], v[168:171], v[40:43], 0
    v_mfma_f32_32x32x16_bf16 v[144:159], v[172:175], v[44:47], v[144:159]
    s_waitcnt vmcnt(12)
    v_cndmask_b32 v54, v54, 0, s[22:23]
    v_cndmask_b32 v55, v55, 0, s[22:23]
    v_cndmask_b32 v48, v48, 0, s[24:25]
    v_cndmask_b32 v49, v49, 0, s[24:25]
    s_nop 1
    v_mfma_f32_32x32x16_bf16 v[128:143], v[168:171], v[48:51], 0
    v_mfma_f32_32x32x16_bf16 v[128:143], v[172:175], v[52:55], v[128:143]
    v_max3_f32 v16, v232, v233, v234
    v_max3_f32 v17, v235, v236, v237
    v_max3_f32 v16, v16, v238, v239
    v_max3_f32 v17, v17, v240, v241
    v_max3_f32 v16, v16, v242, v243
    v_max3_f32 v17, v17, v244, v245
    v_max3_f32 v16, v16, v246, v247
    v_max_f32 v16, v16, v17
    v_mov_b32 v17, v16
    s_nop 1
    v_permlane32_swap_b32 v16, v17
    v_max_f32 v16, v16, v17
    v_sub_f32 v16, 0, v16
    v_cvt_pk_bf16_f32 v16, v16, 0
    v_cndmask_b32 v38, v38, v16, s[22:23]
    v_cndmask_b32 v32, v32, v16, s[24:25]
    v_lshlrev_b32 v8, 16, v16
    s_waitcnt vmcnt(10)
    v_cndmask_b32 v62, v62, 0, s[22:23]
    v_cndmask_b32 v63, v63, 0, s[22:23]
    v_cndmask_b32 v56, v56, 0, s[24:25]
    v_cndmask_b32 v57, v57, 0, s[24:25]
    s_nop 1
    v_mfma_f32_32x32x16_bf16 v[232:247], v[168:171], v[56:59], 0
    v_mfma_f32_32x32x16_bf16 v[232:247], v[172:175], v[60:63], v[232:247]
    v_max3_f32 v16, v144, v145, v146
    v_max3_f32 v17, v147, v148, v149
    v_max3_f32 v16, v16, v150, v151
    v_max3_f32 v17, v17, v152, v153
    v_max3_f32 v16, v16, v154, v155
    v_max3_f32 v17, v17, v156, v157
    v_max3_f32 v16, v16, v158, v159
    v_max_f32 v16, v16, v17
    v_mov_b32 v17, v16
    s_nop 1
    v_permlane32_swap_b32 v16, v17
    v_max_f32 v16, v16, v17
    v_sub_f32 v16, 0, v16
    v_cvt_pk_bf16_f32 v16, v16, 0
    v_cndmask_b32 v46, v46, v16, s[22:23]
    v_cndmask_b32 v40, v40, v16, s[24:25]
    v_lshlrev_b32 v9, 16, v16
    v_max3_f32 v16, v128, v129, v130
    v_max3_f32 v17, v131, v132, v133
    v_max3_f32 v16, v16, v134, v135
    v_max3_f32 v17, v17, v136, v137
    v_max3_f32 v16, v16, v138, v139
    v_max3_f32 v17, v17, v140, v141
    v_max3_f32 v16, v16, v142, v143
    v_max_f32 v16, v16, v17
    v_mov_b32 v17, v16
    s_nop 1
    v_permlane32_swap_b32 v16, v17
    v_max_f32 v16, v16, v17
    v_sub_f32 v16, 0, v16
    v_cvt_pk_bf16_f32 v16, v16, 0
    v_cndmask_b32 v54, v54, v16, s[22:23]
    v_cndmask_b32 v48, v48, v16, s[24:25]
    v_lshlrev_b32 v10, 16, v16
    v_mfma_f32_32x32x16_bf16 v[128:143], v[168:171], v[32:35], 0
    v_mfma_f32_32x32x16_bf16 v[128:143], v[172:175], v[36:39], v[128:143]
    v_max3_f32 v16, v232, v233, v234
    v_max3_f32 v17, v235, v236, v237
    v_max3_f32 v16, v16, v238, v239
    v_max3_f32 v17, v17, v240, v241
    v_max3_f32 v16, v16, v242, v243
    v_max3_f32 v17, v17, v244, v245
    v_max3_f32 v16, v16, v246, v247
    v_max_f32 v16, v16, v17
    v_mov_b32 v17, v16
    s_nop 1
    v_permlane32_swap_b32 v16, v17
    v_max_f32 v16, v16, v17
    v_sub_f32 v16, 0, v16
    v_cvt_pk_bf16_f32 v16, v16, 0
    v_cndmask_b32 v62, v62, v16, s[22:23]
    v_cndmask_b32 v56, v56, v16, s[24:25]
    v_lshlrev_b32 v11, 16, v16
    s_waitcnt vmcnt(8)
    s_mov_b32 s18, 4
.p2align 6
AT_LOOP:
    v_mfma_f32_32x32x16_bf16 v[144:159], v[168:171], v[40:43], 0
    v_exp_f32 v128, v128
    v_exp_f32 v129, v129
    v_exp_f32 v130, v130
    v_mfma_f32_32x32x16_bf16 v[144:159], v[172:175], v[44:47], v[144:159]
    v_exp_f32 v131, v131
    v_exp_f32 v132, v132
    v_exp_f32 v133, v133
    v_mfma_f32_32x32x16_bf16 v[112:127], v[224:227], v[160:163], v[112:127]
    v_exp_f32 v134, v134
    v_exp_f32 v135, v135
    v_exp_f32 v136, v136
    v_mfma_f32_32x32x16_bf16 v[112:127], v[228:231], v[164:167], v[112:127]
    v_exp_f32 v137, v137
    v_exp_f32 v138, v138
    v_exp_f32 v139, v139
    v_cvt_pk_bf16_f32 v160, v128, v129
    v_cvt_pk_bf16_f32 v161, v130, v131
    v_exp_f32 v140, v140
    v_exp_f32 v141, v141
    v_cvt_pk_bf16_f32 v162, v132, v133
    v_cvt_pk_bf16_f32 v163, v134, v135
    v_exp_f32 v142, v142
    v_exp_f32 v143, v143
    v_cvt_pk_bf16_f32 v164, v136, v137
    v_cvt_pk_bf16_f32 v165, v138, v139
    v_cvt_pk_bf16_f32 v166, v140, v141
    v_cvt_pk_bf16_f32 v167, v142, v143
    v_mfma_f32_32x32x16_bf16 v[128:143], v[168:171], v[48:51], 0
    v_exp_f32 v144, v144
    v_exp_f32 v145, v145
    v_exp_f32 v146, v146
    v_mfma_f32_32x32x16_bf16 v[128:143], v[172:175], v[52:55], v[128:143]
    v_exp_f32 v147, v147
    v_exp_f32 v148, v148
    v_exp_f32 v149, v149
    v_mfma_f32_32x32x16_bf16 v[64:79], v[176:179], v[160:163], v[64:79]
    v_exp_f32 v150, v150
    v_exp_f32 v151, v151
    v_exp_f32 v152, v152
    v_mfma_f32_32x32x16_bf16 v[64:79], v[180:183], v[164:167], v[64:79]
    v_exp_f32 v153, v153
    v_exp_f32 v154, v154
    v_exp_f32 v155, v155
    buffer_load_dwordx4 v[216:219], v3, s[8:11], s16 offen sc0 sc1
    buffer_load_dwordx4 v[220:223], v3, s[8:11], s16 offen offset:1024 sc0 sc1
    s_mov_b64 exec, s[28:29]
    buffer_load_dwordx4 v[224:227], v4, s[8:11], s16 offen sc0 sc1
    buffer_load_dwordx4 v[228:231], v4, s[8:11], s16 offen offset:1024 sc0 sc1
    s_mov_b64 exec, -1
    s_add_u32 s16, s16, 2048
    v_cvt_pk_bf16_f32 v160, v144, v145
    v_cvt_pk_bf16_f32 v161, v146, v147
    v_exp_f32 v156, v156
    v_exp_f32 v157, v157
    v_cvt_pk_bf16_f32 v162, v148, v149
    v_cvt_pk_bf16_f32 v163, v150, v151
    v_exp_f32 v158, v158
    v_exp_f32 v159, v159
    v_cvt_pk_bf16_f32 v164, v152, v153
    v_cvt_pk_bf16_f32 v165, v154, v155
    v_cvt_pk_bf16_f32 v166, v156, v157
    v_cvt_pk_bf16_f32 v167, v158, v159
    v_mfma_f32_32x32x16_bf16 v[144:159], v[168:171], v[56:59], 0
    v_exp_f32 v128, v128
    v_exp_f32 v129, v129
    v_exp_f32 v130, v130
    v_mfma_f32_32x32x16_bf16 v[144:159], v[172:175], v[60:63], v[144:159]
    v_exp_f32 v131, v131
    v_exp_f32 v132, v132
    v_exp_f32 v133, v133
    v_mfma_f32_32x32x16_bf16 v[80:95], v[176:179], v[160:163], v[80:95]
    v_exp_f32 v134, v134
    v_exp_f32 v135, v135
    v_exp_f32 v136, v136
    v_mfma_f32_32x32x16_bf16 v[80:95], v[180:183], v[164:167], v[80:95]
    v_exp_f32 v137, v137
    v_exp_f32 v138, v138
    v_exp_f32 v139, v139
    v_cvt_pk_bf16_f32 v160, v128, v129
    v_cvt_pk_bf16_f32 v161, v130, v131
    v_exp_f32 v140, v140
    v_exp_f32 v141, v141
    v_cvt_pk_bf16_f32 v162, v132, v133
    v_cvt_pk_bf16_f32 v163, v134, v135
    v_exp_f32 v142, v142
    v_exp_f32 v143, v143
    v_cvt_pk_bf16_f32 v164, v136, v137
    v_cvt_pk_bf16_f32 v165, v138, v139
    v_cvt_pk_bf16_f32 v166, v140, v141
    v_cvt_pk_bf16_f32 v167, v142, v143
    s_waitcnt vmcnt(8)
    v_mfma_f32_32x32x16_bf16 v[128:143], v[184:187], v[32:35], 0
    v_exp_f32 v144, v144
    v_exp_f32 v145, v145
    v_exp_f32 v146, v146
    v_mfma_f32_32x32x16_bf16 v[128:143], v[188:191], v[36:39], v[128:143]
    v_exp_f32 v147, v147
    v_exp_f32 v148, v148
    v_exp_f32 v149, v149
    v_mfma_f32_32x32x16_bf16 v[96:111], v[176:179], v[160:163], v[96:111]
    v_exp_f32 v150, v150
    v_exp_f32 v151, v151
    v_exp_f32 v152, v152
    v_mfma_f32_32x32x16_bf16 v[96:111], v[180:183], v[164:167], v[96:111]
    v_exp_f32 v153, v153
    v_exp_f32 v154, v154
    v_exp_f32 v155, v155
    v_cvt_pk_bf16_f32 v160, v144, v145
    v_cvt_pk_bf16_f32 v161, v146, v147
    v_exp_f32 v156, v156
    v_exp_f32 v157, v157
    v_cvt_pk_bf16_f32 v162, v148, v149
    v_cvt_pk_bf16_f32 v163, v150, v151
    v_exp_f32 v158, v158
    v_exp_f32 v159, v159
    v_cvt_pk_bf16_f32 v164, v152, v153
    v_cvt_pk_bf16_f32 v165, v154, v155
    v_cvt_pk_bf16_f32 v166, v156, v157
    v_cvt_pk_bf16_f32 v167, v158, v159
    v_mfma_f32_32x32x16_bf16 v[144:159], v[184:187], v[40:43], 0
    v_exp_f32 v128, v128
    v_exp_f32 v129, v129
    v_exp_f32 v130, v130
    v_mfma_f32_32x32x16_bf16 v[144:159], v[188:191], v[44:47], v[144:159]
    v_exp_f32 v131, v131
    v_exp_f32 v132, v132
    v_exp_f32 v133, v133
    v_mfma_f32_32x32x16_bf16 v[112:127], v[176:179], v[160:163], v[112:127]
    v_exp_f32 v134, v134
    v_exp_f32 v135, v135
    v_exp_f32 v136, v136
    v_mfma_f32_32x32x16_bf16 v[112:127], v[180:183], v[164:167], v[112:127]
    v_exp_f32 v137, v137
    v_exp_f32 v138, v138
    v_exp_f32 v139, v139
    v_cvt_pk_bf16_f32 v160, v128, v129
    v_cvt_pk_bf16_f32 v161, v130, v131
    v_exp_f32 v140, v140
    v_exp_f32 v141, v141
    v_cvt_pk_bf16_f32 v162, v132, v133
    v_cvt_pk_bf16_f32 v163, v134, v135
    v_exp_f32 v142, v142
    v_exp_f32 v143, v143
    v_cvt_pk_bf16_f32 v164, v136, v137
    v_cvt_pk_bf16_f32 v165, v138, v139
    v_cvt_pk_bf16_f32 v166, v140, v141
    v_cvt_pk_bf16_f32 v167, v142, v143
    v_mfma_f32_32x32x16_bf16 v[128:143], v[184:187], v[48:51], 0
    v_exp_f32 v144, v144
    v_exp_f32 v145, v145
    v_exp_f32 v146, v146
    v_mfma_f32_32x32x16_bf16 v[128:143], v[188:191], v[52:55], v[128:143]
    v_exp_f32 v147, v147
    v_exp_f32 v148, v148
    v_exp_f32 v149, v149
    v_mfma_f32_32x32x16_bf16 v[64:79], v[192:195], v[160:163], v[64:79]
    v_exp_f32 v150, v150
    v_exp_f32 v151, v151
    v_exp_f32 v152, v152
    v_mfma_f32_32x32x16_bf16 v[64:79], v[196:199], v[164:167], v[64:79]
    v_exp_f32 v153, v153
    v_exp_f32 v154, v154
    v_exp_f32 v155, v155
    buffer_load_dwordx4 v[168:171], v3, s[8:11], s16 offen sc0 sc1
    buffer_load_dwordx4 v[172:175], v3, s[8:11], s16 offen offset:1024 sc0 sc1
    s_mov_b64 exec, s[28:29]
    buffer_load_dwordx4 v[176:179], v4, s[8:11], s16 offen sc0 sc1
    buffer_load_dwordx4 v[180:183], v4, s[8:11], s16 offen offset:1024 sc0 sc1
    s_mov_b64 exec, -1
    s_add_u32 s16, s16, 2048
    v_cvt_pk_bf16_f32 v160, v144, v145
    v_cvt_pk_bf16_f32 v161, v146, v147
    v_exp_f32 v156, v156
    v_exp_f32 v157, v157
    v_cvt_pk_bf16_f32 v162, v148, v149
    v_cvt_pk_bf16_f32 v163, v150, v151
    v_exp_f32 v158, v158
    v_exp_f32 v159, v159
    v_cvt_pk_bf16_f32 v164, v152, v153
    v_cvt_pk_bf16_f32 v165, v154, v155
    v_cvt_pk_bf16_f32 v166, v156, v157
    v_cvt_pk_bf16_f32 v167, v158, v159
    v_mfma_f32_32x32x16_bf16 v[144:159], v[184:187], v[56:59], 0
    v_exp_f32 v128, v128
    v_exp_f32 v129, v129
    v_exp_f32 v130, v130
    v_mfma_f32_32x32x16_bf16 v[144:159], v[188:191], v[60:63], v[144:159]
    v_exp_f32 v131, v131
    v_exp_f32 v132, v132
    v_exp_f32 v133, v133
    v_mfma_f32_32x32x16_bf16 v[80:95], v[192:195], v[160:163], v[80:95]
    v_exp_f32 v134, v134
    v_exp_f32 v135, v135
    v_exp_f32 v136, v136
    v_mfma_f32_32x32x16_bf16 v[80:95], v[196:199], v[164:167], v[80:95]
    v_exp_f32 v137, v137
    v_exp_f32 v138, v138
    v_exp_f32 v139, v139
    v_cvt_pk_bf16_f32 v160, v128, v129
    v_cvt_pk_bf16_f32 v161, v130, v131
    v_exp_f32 v140, v140
    v_exp_f32 v141, v141
    v_cvt_pk_bf16_f32 v162, v132, v133
    v_cvt_pk_bf16_f32 v163, v134, v135
    v_exp_f32 v142, v142
    v_exp_f32 v143, v143
    v_cvt_pk_bf16_f32 v164, v136, v137
    v_cvt_pk_bf16_f32 v165, v138, v139
    v_cvt_pk_bf16_f32 v166, v140, v141
    v_cvt_pk_bf16_f32 v167, v142, v143
    s_waitcnt vmcnt(8)
    v_mfma_f32_32x32x16_bf16 v[128:143], v[200:203], v[32:35], 0
    v_exp_f32 v144, v144
    v_exp_f32 v145, v145
    v_exp_f32 v146, v146
    v_mfma_f32_32x32x16_bf16 v[128:143], v[204:207], v[36:39], v[128:143]
    v_exp_f32 v147, v147
    v_exp_f32 v148, v148
    v_exp_f32 v149, v149
    v_mfma_f32_32x32x16_bf16 v[96:111], v[192:195], v[160:163], v[96:111]
    v_exp_f32 v150, v150
    v_exp_f32 v151, v151
    v_exp_f32 v152, v152
    v_mfma_f32_32x32x16_bf16 v[96:111], v[196:199], v[164:167], v[96:111]
    v_exp_f32 v153, v153
    v_exp_f32 v154, v154
    v_exp_f32 v155, v155
    v_cvt_pk_bf16_f32 v160, v144, v145
    v_cvt_pk_bf16_f32 v161, v146, v147
    v_exp_f32 v156, v156
    v_exp_f32 v157, v157
    v_cvt_pk_bf16_f32 v162, v148, v149
    v_cvt_pk_bf16_f32 v163, v150, v151
    v_exp_f32 v158, v158
    v_exp_f32 v159, v159
    v_cvt_pk_bf16_f32 v164, v152, v153
    v_cvt_pk_bf16_f32 v165, v154, v155
    v_cvt_pk_bf16_f32 v166, v156, v157
    v_cvt_pk_bf16_f32 v167, v158, v159
    v_mfma_f32_32x32x16_bf16 v[144:159], v[200:203], v[40:43], 0
    v_exp_f32 v128, v128
    v_exp_f32 v129, v129
    v_exp_f32 v130, v130
    v_mfma_f32_32x32x16_bf16 v[144:159], v[204:207], v[44:47], v[144:159]
    v_exp_f32 v131, v131
    v_exp_f32 v132, v132
    v_exp_f32 v133, v133
    v_mfma_f32_32x32x16_bf16 v[112:127], v[192:195], v[160:163], v[112:127]
    v_exp_f32 v134, v134
    v_exp_f32 v135, v135
    v_exp_f32 v136, v136
    v_mfma_f32_32x32x16_bf16 v[112:127], v[196:199], v[164:167], v[112:127]
    v_exp_f32 v137, v137
    v_exp_f32 v138, v138
    v_exp_f32 v139, v139
    v_cvt_pk_bf16_f32 v160, v128, v129
    v_cvt_pk_bf16_f32 v161, v130, v131
    v_exp_f32 v140, v140
    v_exp_f32 v141, v141
    v_cvt_pk_bf16_f32 v162, v132, v133
    v_cvt_pk_bf16_f32 v163, v134, v135
    v_exp_f32 v142, v142
    v_exp_f32 v143, v143
    v_cvt_pk_bf16_f32 v164, v136, v137
    v_cvt_pk_bf16_f32 v165, v138, v139
    v_cvt_pk_bf16_f32 v166, v140, v141
    v_cvt_pk_bf16_f32 v167, v142, v143
    v_mfma_f32_32x32x16_bf16 v[128:143], v[200:203], v[48:51], 0
    v_exp_f32 v144, v144
    v_exp_f32 v145, v145
    v_exp_f32 v146, v146
    v_mfma_f32_32x32x16_bf16 v[128:143], v[204:207], v[52:55], v[128:143]
    v_exp_f32 v147, v147
    v_exp_f32 v148, v148
    v_exp_f32 v149, v149
    v_mfma_f32_32x32x16_bf16 v[64:79], v[208:211], v[160:163], v[64:79]
    v_exp_f32 v150, v150
    v_exp_f32 v151, v151
    v_exp_f32 v152, v152
    v_mfma_f32_32x32x16_bf16 v[64:79], v[212:215], v[164:167], v[64:79]
    v_exp_f32 v153, v153
    v_exp_f32 v154, v154
    v_exp_f32 v155, v155
    buffer_load_dwordx4 v[184:187], v3, s[8:11], s16 offen sc0 sc1
    buffer_load_dwordx4 v[188:191], v3, s[8:11], s16 offen offset:1024 sc0 sc1
    s_mov_b64 exec, s[28:29]
    buffer_load_dwordx4 v[192:195], v4, s[8:11], s16 offen sc0 sc1
    buffer_load_dwordx4 v[196:199], v4, s[8:11], s16 offen offset:1024 sc0 sc1
    s_mov_b64 exec, -1
    s_add_u32 s16, s16, 2048
    v_cvt_pk_bf16_f32 v160, v144, v145
    v_cvt_pk_bf16_f32 v161, v146, v147
    v_exp_f32 v156, v156
    v_exp_f32 v157, v157
    v_cvt_pk_bf16_f32 v162, v148, v149
    v_cvt_pk_bf16_f32 v163, v150, v151
    v_exp_f32 v158, v158
    v_exp_f32 v159, v159
    v_cvt_pk_bf16_f32 v164, v152, v153
    v_cvt_pk_bf16_f32 v165, v154, v155
    v_cvt_pk_bf16_f32 v166, v156, v157
    v_cvt_pk_bf16_f32 v167, v158, v159
    v_mfma_f32_32x32x16_bf16 v[144:159], v[200:203], v[56:59], 0
    v_exp_f32 v128, v128
    v_exp_f32 v129, v129
    v_exp_f32 v130, v130
    v_mfma_f32_32x32x16_bf16 v[144:159], v[204:207], v[60:63], v[144:159]
    v_exp_f32 v131, v131
    v_exp_f32 v132, v132
    v_exp_f32 v133, v133
    v_mfma_f32_32x32x16_bf16 v[80:95], v[208:211], v[160:163], v[80:95]
    v_exp_f32 v134, v134
    v_exp_f32 v135, v135
    v_exp_f32 v136, v136
    v_mfma_f32_32x32x16_bf16 v[80:95], v[212:215], v[164:167], v[80:95]
    v_exp_f32 v137, v137
    v_exp_f32 v138, v138
    v_exp_f32 v139, v139
    v_cvt_pk_bf16_f32 v160, v128, v129
    v_cvt_pk_bf16_f32 v161, v130, v131
    v_exp_f32 v140, v140
    v_exp_f32 v141, v141
    v_cvt_pk_bf16_f32 v162, v132, v133
    v_cvt_pk_bf16_f32 v163, v134, v135
    v_exp_f32 v142, v142
    v_exp_f32 v143, v143
    v_cvt_pk_bf16_f32 v164, v136, v137
    v_cvt_pk_bf16_f32 v165, v138, v139
    v_cvt_pk_bf16_f32 v166, v140, v141
    v_cvt_pk_bf16_f32 v167, v142, v143
    s_waitcnt vmcnt(8)
    v_mfma_f32_32x32x16_bf16 v[128:143], v[216:219], v[32:35], 0
    v_exp_f32 v144, v144
    v_exp_f32 v145, v145
    v_exp_f32 v146, v146
    v_mfma_f32_32x32x16_bf16 v[128:143], v[220:223], v[36:39], v[128:143]
    v_exp_f32 v147, v147
    v_exp_f32 v148, v148
    v_exp_f32 v149, v149
    v_mfma_f32_32x32x16_bf16 v[96:111], v[208:211], v[160:163], v[96:111]
    v_exp_f32 v150, v150
    v_exp_f32 v151, v151
    v_exp_f32 v152, v152
    v_mfma_f32_32x32x16_bf16 v[96:111], v[212:215], v[164:167], v[96:111]
    v_exp_f32 v153, v153
    v_exp_f32 v154, v154
    v_exp_f32 v155, v155
    v_cvt_pk_bf16_f32 v160, v144, v145
    v_cvt_pk_bf16_f32 v161, v146, v147
    v_exp_f32 v156, v156
    v_exp_f32 v157, v157
    v_cvt_pk_bf16_f32 v162, v148, v149
    v_cvt_pk_bf16_f32 v163, v150, v151
    v_exp_f32 v158, v158
    v_exp_f32 v159, v159
    v_cvt_pk_bf16_f32 v164, v152, v153
    v_cvt_pk_bf16_f32 v165, v154, v155
    v_cvt_pk_bf16_f32 v166, v156, v157
    v_cvt_pk_bf16_f32 v167, v158, v159
    v_mfma_f32_32x32x16_bf16 v[144:159], v[216:219], v[40:43], 0
    v_exp_f32 v128, v128
    v_exp_f32 v129, v129
    v_exp_f32 v130, v130
    v_mfma_f32_32x32x16_bf16 v[144:159], v[220:223], v[44:47], v[144:159]
    v_exp_f32 v131, v131
    v_exp_f32 v132, v132
    v_exp_f32 v133, v133
    v_mfma_f32_32x32x16_bf16 v[112:127], v[208:211], v[160:163], v[112:127]
    v_exp_f32 v134, v134
    v_exp_f32 v135, v135
    v_exp_f32 v136, v136
    v_mfma_f32_32x32x16_bf16 v[112:127], v[212:215], v[164:167], v[112:127]
    v_exp_f32 v137, v137
    v_exp_f32 v138, v138
    v_exp_f32 v139, v139
    v_cvt_pk_bf16_f32 v160, v128, v129
    v_cvt_pk_bf16_f32 v161, v130, v131
    v_exp_f32 v140, v140
    v_exp_f32 v141, v141
    v_cvt_pk_bf16_f32 v162, v132, v133
    v_cvt_pk_bf16_f32 v163, v134, v135
    v_exp_f32 v142, v142
    v_exp_f32 v143, v143
    v_cvt_pk_bf16_f32 v164, v136, v137
    v_cvt_pk_bf16_f32 v165, v138, v139
    v_cvt_pk_bf16_f32 v166, v140, v141
    v_cvt_pk_bf16_f32 v167, v142, v143
    v_mfma_f32_32x32x16_bf16 v[128:143], v[216:219], v[48:51], 0
    v_exp_f32 v144, v144
    v_exp_f32 v145, v145
    v_exp_f32 v146, v146
    v_mfma_f32_32x32x16_bf16 v[128:143], v[220:223], v[52:55], v[128:143]
    v_exp_f32 v147, v147
    v_exp_f32 v148, v148
    v_exp_f32 v149, v149
    v_mfma_f32_32x32x16_bf16 v[64:79], v[224:227], v[160:163], v[64:79]
    v_exp_f32 v150, v150
    v_exp_f32 v151, v151
    v_exp_f32 v152, v152
    v_mfma_f32_32x32x16_bf16 v[64:79], v[228:231], v[164:167], v[64:79]
    v_exp_f32 v153, v153
    v_exp_f32 v154, v154
    v_exp_f32 v155, v155
    buffer_load_dwordx4 v[200:203], v3, s[8:11], s16 offen sc0 sc1
    buffer_load_dwordx4 v[204:207], v3, s[8:11], s16 offen offset:1024 sc0 sc1
    s_mov_b64 exec, s[28:29]
    buffer_load_dwordx4 v[208:211], v4, s[8:11], s16 offen sc0 sc1
    buffer_load_dwordx4 v[212:215], v4, s[8:11], s16 offen offset:1024 sc0 sc1
    s_mov_b64 exec, -1
    s_add_u32 s16, s16, 2048
    v_cvt_pk_bf16_f32 v160, v144, v145
    v_cvt_pk_bf16_f32 v161, v146, v147
    v_exp_f32 v156, v156
    v_exp_f32 v157, v157
    v_cvt_pk_bf16_f32 v162, v148, v149
    v_cvt_pk_bf16_f32 v163, v150, v151
    v_exp_f32 v158, v158
    v_exp_f32 v159, v159
    v_cvt_pk_bf16_f32 v164, v152, v153
    v_cvt_pk_bf16_f32 v165, v154, v155
    v_cvt_pk_bf16_f32 v166, v156, v157
    v_cvt_pk_bf16_f32 v167, v158, v159
    v_mfma_f32_32x32x16_bf16 v[144:159], v[216:219], v[56:59], 0
    v_exp_f32 v128, v128
    v_exp_f32 v129, v129
    v_exp_f32 v130, v130
    v_mfma_f32_32x32x16_bf16 v[144:159], v[220:223], v[60:63], v[144:159]
    v_exp_f32 v131, v131
    v_exp_f32 v132, v132
    v_exp_f32 v133, v133
    v_mfma_f32_32x32x16_bf16 v[80:95], v[224:227], v[160:163], v[80:95]
    v_exp_f32 v134, v134
    v_exp_f32 v135, v135
    v_exp_f32 v136, v136
    v_mfma_f32_32x32x16_bf16 v[80:95], v[228:231], v[164:167], v[80:95]
    v_exp_f32 v137, v137
    v_exp_f32 v138, v138
    v_exp_f32 v139, v139
    v_cvt_pk_bf16_f32 v160, v128, v129
    v_cvt_pk_bf16_f32 v161, v130, v131
    v_exp_f32 v140, v140
    v_exp_f32 v141, v141
    v_cvt_pk_bf16_f32 v162, v132, v133
    v_cvt_pk_bf16_f32 v163, v134, v135
    v_exp_f32 v142, v142
    v_exp_f32 v143, v143
    v_cvt_pk_bf16_f32 v164, v136, v137
    v_cvt_pk_bf16_f32 v165, v138, v139
    v_cvt_pk_bf16_f32 v166, v140, v141
    v_cvt_pk_bf16_f32 v167, v142, v143
    s_waitcnt vmcnt(8)
    v_mfma_f32_32x32x16_bf16 v[128:143], v[168:171], v[32:35], 0
    v_exp_f32 v144, v144
    v_exp_f32 v145, v145
    v_exp_f32 v146, v146
    v_mfma_f32_32x32x16_bf16 v[128:143], v[172:175], v[36:39], v[128:143]
    v_exp_f32 v147, v147
    v_exp_f32 v148, v148
    v_exp_f32 v149, v149
    v_mfma_f32_32x32x16_bf16 v[96:111], v[224:227], v[160:163], v[96:111]
    v_exp_f32 v150, v150
    v_exp_f32 v151, v151
    v_exp_f32 v152, v152
    v_mfma_f32_32x32x16_bf16 v[96:111], v[228:231], v[164:167], v[96:111]
    v_exp_f32 v153, v153
    v_exp_f32 v154, v154
    v_exp_f32 v155, v155
    v_cvt_pk_bf16_f32 v160, v144, v145
    v_cvt_pk_bf16_f32 v161, v146, v147
    v_exp_f32 v156, v156
    v_exp_f32 v157, v157
    v_cvt_pk_bf16_f32 v162, v148, v149
    v_cvt_pk_bf16_f32 v163, v150, v151
    v_exp_f32 v158, v158
    v_exp_f32 v159, v159
    v_cvt_pk_bf16_f32 v164, v152, v153
    v_cvt_pk_bf16_f32 v165, v154, v155
    v_cvt_pk_bf16_f32 v166, v156, v157
    v_cvt_pk_bf16_f32 v167, v158, v159
    s_sub_u32 s18, s18, 1
    s_cmp_lg_u32 s18, 0
    s_cbranch_scc1 AT_LOOP
    v_mfma_f32_32x32x16_bf16 v[112:127], v[224:227], v[160:163], v[112:127]
    v_mfma_f32_32x32x16_bf16 v[112:127], v[228:231], v[164:167], v[112:127]
    s_mov_b32 s38, 0x5d800000
    s_mov_b32 s39, 0x21800000
    s_mov_b64 s[34:35], 0
    v_cmp_nge_f32 vcc, s38, v76
    s_nop 0
    s_or_b64 s[34:35], s[34:35], vcc
    v_cmp_gt_f32 vcc, s39, v76
    s_nop 0
    s_or_b64 s[34:35], s[34:35], vcc
    v_cmp_nge_f32 vcc, s38, v92
    s_nop 0
    s_or_b64 s[34:35], s[34:35], vcc
    v_cmp_gt_f32 vcc, s39, v92
    s_nop 0
    s_or_b64 s[34:35], s[34:35], vcc
    v_cmp_nge_f32 vcc, s38, v108
    s_nop 0
    s_or_b64 s[34:35], s[34:35], vcc
    v_cmp_gt_f32 vcc, s39, v108
    s_nop 0
    s_or_b64 s[34:35], s[34:35], vcc
    v_cmp_nge_f32 vcc, s38, v124
    s_nop 0
    s_or_b64 s[34:35], s[34:35], vcc
    v_cmp_gt_f32 vcc, s39, v124
    s_nop 0
    s_or_b64 s[34:35], s[34:35], vcc
    s_and_b64 s[34:35], s[34:35], s[20:21]
    s_cselect_b32 s38, 1, 0
    s_andn2_b32 s38, s38, s36
    s_cbranch_scc1 AT_FB
    v_and_b32 v5, 31, v1
    v_lshlrev_b32 v5, 2, v5
    s_add_u32 s17, s12, 1
    s_and_b32 s17, s17, 3
    s_mul_i32 s19, s17, 384
    s_add_u32 s19, s19, 49152
    v_add_u32 v6, s19, v5
    ds_write_b32 v6, v9
    s_mul_i32 s17, s17, 12288
    s_add_u32 s17, s17, 0
    v_add_u32 v13, s17, v2
    s_add_u32 s17, s12, 2
    s_and_b32 s17, s17, 3
    s_mul_i32 s19, s17, 384
    s_add_u32 s19, s19, 49280
    v_add_u32 v6, s19, v5
    ds_write_b32 v6, v10
    s_mul_i32 s17, s17, 12288
    s_add_u32 s17, s17, 4096
    v_add_u32 v14, s17, v2
    s_add_u32 s17, s12, 3
    s_and_b32 s17, s17, 3
    s_mul_i32 s19, s17, 384
    s_add_u32 s19, s19, 49408
    v_add_u32 v6, s19, v5
    ds_write_b32 v6, v11
    s_mul_i32 s17, s17, 12288
    s_add_u32 s17, s17, 8192
    v_add_u32 v15, s17, v2
    ds_write_b128 v13, v[80:83] offset:0
    ds_write_b128 v13, v[84:87] offset:1024
    ds_write_b128 v13, v[88:91] offset:2048
    ds_write_b128 v13, v[92:95] offset:3072
    ds_write_b128 v14, v[96:99] offset:0
    ds_write_b128 v14, v[100:103] offset:1024
    ds_write_b128 v14, v[104:107] offset:2048
    ds_write_b128 v14, v[108:111] offset:3072
    ds_write_b128 v15, v[112:115] offset:0
    ds_write_b128 v15, v[116:119] offset:1024
    ds_write_b128 v15, v[120:123] offset:2048
    ds_write_b128 v15, v[124:127] offset:3072
    s_lshl_b32 s17, s12, 2
    v_add_u32 v6, s17, v22
    s_waitcnt lgkmcnt(0)
    ds_write_b32 v6, v21 offset:0
    s_mul_i32 s17, s12, 12288
    v_add_u32 v12, s17, v2
    s_mul_i32 s17, s12, 384
    v_add_u32 v5, s17, v5
    s_mov_b32 s62, 0
    s_branch LW2_1
LW2:
    s_sleep 1
LW2_1:
    s_add_u32 s62, s62, 1
    s_cmp_gt_u32 s62, 0x40000
    s_cbranch_scc1 LW2_X
    ds_read_b128 v[24:27], v22 offset:0
    s_waitcnt lgkmcnt(0)
    v_and_b32 v24, v24, v25
    v_and_b32 v26, v26, v27
    v_and_b32 v24, v24, v26
    s_nop 0
    v_readfirstlane_b32 s17, v24
    s_nop 0
    s_cmp_eq_u32 s17, 1
    s_cbranch_scc0 LW2
LW2_X:
    ds_read_b32 v24, v5 offset:49152
    ds_read_b32 v25, v5 offset:49280
    ds_read_b32 v26, v5 offset:49408
    ds_read_b128 v[128:131], v12 offset:0
    ds_read_b128 v[132:135], v12 offset:1024
    ds_read_b128 v[136:139], v12 offset:2048
    ds_read_b128 v[140:143], v12 offset:3072
    ds_read_b128 v[144:147], v12 offset:4096
    ds_read_b128 v[148:151], v12 offset:5120
    ds_read_b128 v[152:155], v12 offset:6144
    ds_read_b128 v[156:159], v12 offset:7168
    ds_read_b128 v[168:171], v12 offset:8192
    ds_read_b128 v[172:175], v12 offset:9216
    ds_read_b128 v[176:179], v12 offset:10240
    ds_read_b128 v[180:183], v12 offset:11264
    s_waitcnt lgkmcnt(12)
    v_min_f32 v16, v8, v24
    v_min3_f32 v16, v16, v25, v26
    v_sub_f32 v17, v16, v8
    v_sub_f32 v24, v16, v24
    v_sub_f32 v25, v16, v25
    v_sub_f32 v26, v16, v26
    v_exp_f32 v17, v17
    v_exp_f32 v24, v24
    v_exp_f32 v25, v25
    v_exp_f32 v26, v26
    v_mul_f32 v64, v64, v17
    v_mul_f32 v65, v65, v17
    v_mul_f32 v66, v66, v17
    v_mul_f32 v67, v67, v17
    v_mul_f32 v68, v68, v17
    v_mul_f32 v69, v69, v17
    v_mul_f32 v70, v70, v17
    v_mul_f32 v71, v71, v17
    v_mul_f32 v72, v72, v17
    v_mul_f32 v73, v73, v17
    v_mul_f32 v74, v74, v17
    v_mul_f32 v75, v75, v17
    v_mul_f32 v76, v76, v17
    v_mul_f32 v77, v77, v17
    v_mul_f32 v78, v78, v17
    v_mul_f32 v79, v79, v17
    s_waitcnt lgkmcnt(8)
    v_fmac_f32 v64, v128, v24
    v_fmac_f32 v65, v129, v24
    v_fmac_f32 v66, v130, v24
    v_fmac_f32 v67, v131, v24
    v_fmac_f32 v68, v132, v24
    v_fmac_f32 v69, v133, v24
    v_fmac_f32 v70, v134, v24
    v_fmac_f32 v71, v135, v24
    v_fmac_f32 v72, v136, v24
    v_fmac_f32 v73, v137, v24
    v_fmac_f32 v74, v138, v24
    v_fmac_f32 v75, v139, v24
    v_fmac_f32 v76, v140, v24
    v_fmac_f32 v77, v141, v24
    v_fmac_f32 v78, v142, v24
    v_fmac_f32 v79, v143, v24
    s_waitcnt lgkmcnt(4)
    v_fmac_f32 v64, v144, v25
    v_fmac_f32 v65, v145, v25
    v_fmac_f32 v66, v146, v25
    v_fmac_f32 v67, v147, v25
    v_fmac_f32 v68, v148, v25
    v_fmac_f32 v69, v149, v25
    v_fmac_f32 v70, v150, v25
    v_fmac_f32 v71, v151, v25
    v_fmac_f32 v72, v152, v25
    v_fmac_f32 v73, v153, v25
    v_fmac_f32 v74, v154, v25
    v_fmac_f32 v75, v155, v25
    v_fmac_f32 v76, v156, v25
    v_fmac_f32 v77, v157, v25
    v_fmac_f32 v78, v158, v25
    v_fmac_f32 v79, v159, v25
    s_waitcnt lgkmcnt(0)
    v_fmac_f32 v64, v168, v26
    v_fmac_f32 v65, v169, v26
    v_fmac_f32 v66, v170, v26
    v_fmac_f32 v67, v171, v26
    v_fmac_f32 v68, v172, v26
    v_fmac_f32 v69, v173, v26
    v_fmac_f32 v70, v174, v26
    v_fmac_f32 v71, v175, v26
    v_fmac_f32 v72, v176, v26
    v_fmac_f32 v73, v177, v26
    v_fmac_f32 v74, v178, v26
    v_fmac_f32 v75, v179, v26
    v_fmac_f32 v76, v180, v26
    v_fmac_f32 v77, v181, v26
    v_fmac_f32 v78, v182, v26
    v_fmac_f32 v79, v183, v26
    v_mov_b32 v18, v76
    v_mov_b32 v19, v76
    s_nop 1
    v_permlane32_swap_b32 v18, v19
    v_rcp_f32 v19, v19
    s_nop 0
    v_mul_f32 v64, v64, v19
    v_mul_f32 v65, v65, v19
    v_mul_f32 v66, v66, v19
    v_mul_f32 v67, v67, v19
    v_mul_f32 v68, v68, v19
    v_mul_f32 v69, v69, v19
    v_mul_f32 v70, v70, v19
    v_mul_f32 v71, v71, v19
    v_mul_f32 v72, v72, v19
    v_mul_f32 v73, v73, v19
    v_mul_f32 v74, v74, v19
    v_mul_f32 v75, v75, v19
    v_mul_f32 v76, v76, v19
    v_mul_f32 v77, v77, v19
    v_mul_f32 v78, v78, v19
    v_mul_f32 v79, v79, v19
    v_cvt_pk_bf16_f32 v160, v64, v65
    v_cvt_pk_bf16_f32 v161, v66, v67
    v_cvt_pk_bf16_f32 v162, v68, v69
    v_cvt_pk_bf16_f32 v163, v70, v71
    v_cvt_pk_bf16_f32 v164, v72, v73
    v_cvt_pk_bf16_f32 v165, v74, v75
    v_cvt_pk_bf16_f32 v166, v76, v77
    v_cvt_pk_bf16_f32 v167, v78, v79
    v_cndmask_b32 v166, v166, 0, s[20:21]
    v_cndmask_b32 v167, v167, 0, s[20:21]
    s_lshl_b32 s17, s14, 2
    s_add_u32 s18, s17, s12
    s_mul_i32 s17, s18, 147456
    s_lshl_b32 s19, s13, 11
    s_add_u32 s17, s17, s19
    s_add_u32 s17, s17, 6406144
    buffer_store_dwordx4 v[160:163], v2, s[8:11], s17 offen sc0 sc1
    buffer_store_dwordx4 v[164:167], v2, s[8:11], s17 offen offset:1024 sc0 sc1
    s_lshl_b32 s17, s18, 4
    s_add_u32 s17, s17, s13
    s_lshl_b32 s17, s17, 7
    s_add_u32 s17, s17, 20054016
    v_mov_b32 v5, s94
    s_waitcnt vmcnt(0)
    s_mov_b64 exec, 1
    buffer_store_dword v5, v20, s[8:11], s17 offen sc0 sc1
    s_mov_b64 exec, -1
    s_endpgm
AT_FB:
    s_mov_b32 s36, 1
    s_waitcnt vmcnt(0)
    v_mov_b32 v24, 0xff800000
    v_mov_b32 v25, 0xff800000
    v_mov_b32 v26, 0xff800000
    v_mov_b32 v27, 0xff800000
    s_mov_b32 s16, s37
    s_mov_b32 s38, 16
FB_LOOP:
    buffer_load_dwordx4 v[168:171], v3, s[8:11], s16 offen sc0 sc1
    buffer_load_dwordx4 v[172:175], v3, s[8:11], s16 offen offset:1024 sc0 sc1
    s_add_u32 s16, s16, 2048
    s_waitcnt vmcnt(0)
    v_mfma_f32_32x32x16_bf16 v[128:143], v[168:171], v[32:35], 0
    v_mfma_f32_32x32x16_bf16 v[128:143], v[172:175], v[36:39], v[128:143]
    s_nop 11
    v_max3_f32 v24, v24, v128, v129
    v_max3_f32 v24, v24, v130, v131
    v_max3_f32 v24, v24, v132, v133
    v_max3_f32 v24, v24, v134, v135
    v_max3_f32 v24, v24, v136, v137
    v_max3_f32 v24, v24, v138, v139
    v_max3_f32 v24, v24, v140, v141
    v_max3_f32 v24, v24, v142, v143
    v_mfma_f32_32x32x16_bf16 v[144:159], v[168:171], v[40:43], 0
    v_mfma_f32_32x32x16_bf16 v[144:159], v[172:175], v[44:47], v[144:159]
    s_nop 11
    v_max3_f32 v25, v25, v144, v145
    v_max3_f32 v25, v25, v146, v147
    v_max3_f32 v25, v25, v148, v149
    v_max3_f32 v25, v25, v150, v151
    v_max3_f32 v25, v25, v152, v153
    v_max3_f32 v25, v25, v154, v155
    v_max3_f32 v25, v25, v156, v157
    v_max3_f32 v25, v25, v158, v159
    v_mfma_f32_32x32x16_bf16 v[128:143], v[168:171], v[48:51], 0
    v_mfma_f32_32x32x16_bf16 v[128:143], v[172:175], v[52:55], v[128:143]
    s_nop 11
    v_max3_f32 v26, v26, v128, v129
    v_max3_f32 v26, v26, v130, v131
    v_max3_f32 v26, v26, v132, v133
    v_max3_f32 v26, v26, v134, v135
    v_max3_f32 v26, v26, v136, v137
    v_max3_f32 v26, v26, v138, v139
    v_max3_f32 v26, v26, v140, v141
    v_max3_f32 v26, v26, v142, v143
    v_mfma_f32_32x32x16_bf16 v[144:159], v[168:171], v[56:59], 0
    v_mfma_f32_32x32x16_bf16 v[144:159], v[172:175], v[60:63], v[144:159]
    s_nop 11
    v_max3_f32 v27, v27, v144, v145
    v_max3_f32 v27, v27, v146, v147
    v_max3_f32 v27, v27, v148, v149
    v_max3_f32 v27, v27, v150, v151
    v_max3_f32 v27, v27, v152, v153
    v_max3_f32 v27, v27, v154, v155
    v_max3_f32 v27, v27, v156, v157
    v_max3_f32 v27, v27, v158, v159
    s_sub_u32 s38, s38, 1
    s_cmp_lg_u32 s38, 0
    s_cbranch_scc1 FB_LOOP
    s_mov_b32 s38, 0xffff0000
    v_mov_b32 v17, v24
    s_nop 1
    v_permlane32_swap_b32 v24, v17
    v_max_f32 v24, v24, v17
    v_sub_f32 v24, 0, v24
    v_cvt_pk_bf16_f32 v16, v24, 0
    v_lshlrev_b32 v17, 16, v16
    v_add_f32 v8, v8, v17
    v_sub_f32 v24, v24, v17
    v_cvt_pk_bf16_f32 v18, v24, 0
    v_lshlrev_b32 v18, 16, v18
    v_add_f32 v8, v8, v18
    v_sub_f32 v19, v24, v18
    v_cvt_pk_bf16_f32 v18, v24, v19
    v_and_b32 v19, s38, v18
    v_add_f32 v8, v8, v19
    v_and_b32 v17, 0xffff, v38
    v_lshl_or_b32 v17, v16, 16, v17
    v_cndmask_b32 v38, v38, v17, s[22:23]
    v_cndmask_b32 v39, v39, v18, s[22:23]
    v_and_b32 v17, 0xffff, v32
    v_lshl_or_b32 v17, v16, 16, v17
    v_cndmask_b32 v32, v32, v17, s[24:25]
    v_cndmask_b32 v33, v33, v18, s[24:25]
    v_mov_b32 v17, v25
    s_nop 1
    v_permlane32_swap_b32 v25, v17
    v_max_f32 v25, v25, v17
    v_sub_f32 v25, 0, v25
    v_cvt_pk_bf16_f32 v16, v25, 0
    v_lshlrev_b32 v17, 16, v16
    v_add_f32 v9, v9, v17
    v_sub_f32 v25, v25, v17
    v_cvt_pk_bf16_f32 v18, v25, 0
    v_lshlrev_b32 v18, 16, v18
    v_add_f32 v9, v9, v18
    v_sub_f32 v19, v25, v18
    v_cvt_pk_bf16_f32 v18, v25, v19
    v_and_b32 v19, s38, v18
    v_add_f32 v9, v9, v19
    v_and_b32 v17, 0xffff, v46
    v_lshl_or_b32 v17, v16, 16, v17
    v_cndmask_b32 v46, v46, v17, s[22:23]
    v_cndmask_b32 v47, v47, v18, s[22:23]
    v_and_b32 v17, 0xffff, v40
    v_lshl_or_b32 v17, v16, 16, v17
    v_cndmask_b32 v40, v40, v17, s[24:25]
    v_cndmask_b32 v41, v41, v18, s[24:25]
    v_mov_b32 v17, v26
    s_nop 1
    v_permlane32_swap_b32 v26, v17
    v_max_f32 v26, v26, v17
    v_sub_f32 v26, 0, v26
    v_cvt_pk_bf16_f32 v16, v26, 0
    v_lshlrev_b32 v17, 16, v16
    v_add_f32 v10, v10, v17
    v_sub_f32 v26, v26, v17
    v_cvt_pk_bf16_f32 v18, v26, 0
    v_lshlrev_b32 v18, 16, v18
    v_add_f32 v10, v10, v18
    v_sub_f32 v19, v26, v18
    v_cvt_pk_bf16_f32 v18, v26, v19
    v_and_b32 v19, s38, v18
    v_add_f32 v10, v10, v19
    v_and_b32 v17, 0xffff, v54
    v_lshl_or_b32 v17, v16, 16, v17
    v_cndmask_b32 v54, v54, v17, s[22:23]
    v_cndmask_b32 v55, v55, v18, s[22:23]
    v_and_b32 v17, 0xffff, v48
    v_lshl_or_b32 v17, v16, 16, v17
    v_cndmask_b32 v48, v48, v17, s[24:25]
    v_cndmask_b32 v49, v49, v18, s[24:25]
    v_mov_b32 v17, v27
    s_nop 1
    v_permlane32_swap_b32 v27, v17
    v_max_f32 v27, v27, v17
    v_sub_f32 v27, 0, v27
    v_cvt_pk_bf16_f32 v16, v27, 0
    v_lshlrev_b32 v17, 16, v16
    v_add_f32 v11, v11, v17
    v_sub_f32 v27, v27, v17
    v_cvt_pk_bf16_f32 v18, v27, 0
    v_lshlrev_b32 v18, 16, v18
    v_add_f32 v11, v11, v18
    v_sub_f32 v19, v27, v18
    v_cvt_pk_bf16_f32 v18, v27, v19
    v_and_b32 v19, s38, v18
    v_add_f32 v11, v11, v19
    v_and_b32 v17, 0xffff, v62
    v_lshl_or_b32 v17, v16, 16, v17
    v_cndmask_b32 v62, v62, v17, s[22:23]
    v_cndmask_b32 v63, v63, v18, s[22:23]
    v_and_b32 v17, 0xffff, v56
    v_lshl_or_b32 v17, v16, 16, v17
    v_cndmask_b32 v56, v56, v17, s[24:25]
    v_cndmask_b32 v57, v57, v18, s[24:25]
    s_mov_b32 s16, s37
    buffer_load_dwordx4 v[168:171], v3, s[8:11], s16 offen sc0 sc1
    buffer_load_dwordx4 v[172:175], v3, s[8:11], s16 offen offset:1024 sc0 sc1
    s_mov_b64 exec, s[28:29]
    buffer_load_dwordx4 v[176:179], v4, s[8:11], s16 offen sc0 sc1
    buffer_load_dwordx4 v[180:183], v4, s[8:11], s16 offen offset:1024 sc0 sc1
    s_mov_b64 exec, -1
    s_add_u32 s16, s16, 2048
    buffer_load_dwordx4 v[184:187], v3, s[8:11], s16 offen sc0 sc1
    buffer_load_dwordx4 v[188:191], v3, s[8:11], s16 offen offset:1024 sc0 sc1
    s_mov_b64 exec, s[28:29]
    buffer_load_dwordx4 v[192:195], v4, s[8:11], s16 offen sc0 sc1
    buffer_load_dwordx4 v[196:199], v4, s[8:11], s16 offen offset:1024 sc0 sc1
    s_mov_b64 exec, -1
    s_add_u32 s16, s16, 2048
    buffer_load_dwordx4 v[200:203], v3, s[8:11], s16 offen sc0 sc1
    buffer_load_dwordx4 v[204:207], v3, s[8:11], s16 offen offset:1024 sc0 sc1
    s_mov_b64 exec, s[28:29]
    buffer_load_dwordx4 v[208:211], v4, s[8:11], s16 offen sc0 sc1
    buffer_load_dwordx4 v[212:215], v4, s[8:11], s16 offen offset:1024 sc0 sc1
    s_mov_b64 exec, -1
    s_add_u32 s16, s16, 2048
    v_mov_b32 v64, 0
    v_mov_b32 v65, 0
    v_mov_b32 v66, 0
    v_mov_b32 v67, 0
    v_mov_b32 v68, 0
    v_mov_b32 v69, 0
    v_mov_b32 v70, 0
    v_mov_b32 v71, 0
    v_mov_b32 v72, 0
    v_mov_b32 v73, 0
    v_mov_b32 v74, 0
    v_mov_b32 v75, 0
    v_mov_b32 v76, 0
    v_mov_b32 v77, 0
    v_mov_b32 v78, 0
    v_mov_b32 v79, 0
    v_mov_b32 v80, 0
    v_mov_b32 v81, 0
    v_mov_b32 v82, 0
    v_mov_b32 v83, 0
    v_mov_b32 v84, 0
    v_mov_b32 v85, 0
    v_mov_b32 v86, 0
    v_mov_b32 v87, 0
    v_mov_b32 v88, 0
    v_mov_b32 v89, 0
    v_mov_b32 v90, 0
    v_mov_b32 v91, 0
    v_mov_b32 v92, 0
    v_mov_b32 v93, 0
    v_mov_b32 v94, 0
    v_mov_b32 v95, 0
    v_mov_b32 v96, 0
    v_mov_b32 v97, 0
    v_mov_b32 v98, 0
    v_mov_b32 v99, 0
    v_mov_b32 v100, 0
    v_mov_b32 v101, 0
    v_mov_b32 v102, 0
    v_mov_b32 v103, 0
    v_mov_b32 v104, 0
    v_mov_b32 v105, 0
    v_mov_b32 v106, 0
    v_mov_b32 v107, 0
    v_mov_b32 v108, 0
    v_mov_b32 v109, 0
    v_mov_b32 v110, 0
    v_mov_b32 v111, 0
    v_mov_b32 v112, 0
    v_mov_b32 v113, 0
    v_mov_b32 v114, 0
    v_mov_b32 v115, 0
    v_mov_b32 v116, 0
    v_mov_b32 v117, 0
    v_mov_b32 v118, 0
    v_mov_b32 v119, 0
    v_mov_b32 v120, 0
    v_mov_b32 v121, 0
    v_mov_b32 v122, 0
    v_mov_b32 v123, 0
    v_mov_b32 v124, 0
    v_mov_b32 v125, 0
    v_mov_b32 v126, 0
    v_mov_b32 v127, 0
    v_mov_b32 v160, 0
    v_mov_b32 v161, 0
    v_mov_b32 v162, 0
    v_mov_b32 v163, 0
    v_mov_b32 v164, 0
    v_mov_b32 v165, 0
    v_mov_b32 v166, 0
    v_mov_b32 v167, 0
    s_waitcnt vmcnt(8)
    v_mfma_f32_32x32x16_bf16 v[128:143], v[168:171], v[32:35], 0
    v_mfma_f32_32x32x16_bf16 v[128:143], v[172:175], v[36:39], v[128:143]
    s_mov_b32 s18, 4
    s_nop 15
    s_branch AT_LOOP
MG_LOADER:
    s_sub_u32 s12, s12, 4
    v_lshrrev_b32 v3, 3, v1
    v_and_b32 v5, 7, v1
    v_lshrrev_b32 v4, 4, v1
    v_xor_b32 v4, v4, v5
    v_lshlrev_b32 v4, 4, v4
    v_mul_u32_u24 v20, 896, v3
    v_add_u32 v20, v20, v4
    v_xor_b32 v21, 64, v20
    v_add_u32 v21, 7168, v21
    v_add_u32 v22, 14336, v20
    v_add_u32 v23, 14336, v21
    s_lshl_b32 s25, s14, 2
    s_add_u32 s25, s25, s12
    s_mul_i32 s23, s25, 28672
    s_mul_i32 s84, s12, 24576
    s_add_u32 s84, s84, 57344
    s_waitcnt lgkmcnt(0)
    s_mov_b32 s40, s52
    s_and_b32 s41, s53, 0xffff
    s_mov_b32 s42, 1835008
    s_mov_b32 s43, 0x00020000
    s_mov_b32 s33, 0
    s_mov_b32 s34, 0
    s_add_u32 s85, s84, 0
    s_mov_b32 m0, s85
    s_add_u32 s85, s23, 0
    buffer_load_dwordx4 v20, s[40:43], s85 offen lds
    s_add_u32 s85, s84, 1024
    s_mov_b32 m0, s85
    s_add_u32 s85, s23, 0
    buffer_load_dwordx4 v21, s[40:43], s85 offen lds
    s_add_u32 s85, s84, 2048
    s_mov_b32 m0, s85
    s_add_u32 s85, s23, 0
    buffer_load_dwordx4 v22, s[40:43], s85 offen lds
    s_add_u32 s85, s84, 3072
    s_mov_b32 m0, s85
    s_add_u32 s85, s23, 0
    buffer_load_dwordx4 v23, s[40:43], s85 offen lds
    s_add_u32 s85, s84, 4096
    s_mov_b32 m0, s85
    s_add_u32 s85, s23, 128
    buffer_load_dwordx4 v20, s[40:43], s85 offen lds
    s_add_u32 s85, s84, 5120
    s_mov_b32 m0, s85
    s_add_u32 s85, s23, 128
    buffer_load_dwordx4 v21, s[40:43], s85 offen lds
    s_add_u32 s85, s84, 6144
    s_mov_b32 m0, s85
    s_add_u32 s85, s23, 128
    buffer_load_dwordx4 v22, s[40:43], s85 offen lds
    s_add_u32 s85, s84, 7168
    s_mov_b32 m0, s85
    s_add_u32 s85, s23, 128
    buffer_load_dwordx4 v23, s[40:43], s85 offen lds
    s_add_u32 s85, s84, 8192
    s_mov_b32 m0, s85
    s_add_u32 s85, s23, 256
    buffer_load_dwordx4 v20, s[40:43], s85 offen lds
    s_add_u32 s85, s84, 9216
    s_mov_b32 m0, s85
    s_add_u32 s85, s23, 256
    buffer_load_dwordx4 v21, s[40:43], s85 offen lds
    s_add_u32 s85, s84, 10240
    s_mov_b32 m0, s85
    s_add_u32 s85, s23, 256
    buffer_load_dwordx4 v22, s[40:43], s85 offen lds
    s_add_u32 s85, s84, 11264
    s_mov_b32 m0, s85
    s_add_u32 s85, s23, 256
    buffer_load_dwordx4 v23, s[40:43], s85 offen lds
    v_lshrrev_b32 v3, 3, v1
    v_and_b32 v5, 7, v1
    v_bfe_u32 v4, v1, 4, 1
    v_lshlrev_b32 v4, 2, v4
    v_xor_b32 v4, v4, v5
    v_lshlrev_b32 v4, 4, v4
    v_mul_u32_u24 v15, 2688, v3
    v_add_u32 v15, v15, v4
    v_mul_u32_u24 v16, 3584, v3
    v_add_u32 v16, v16, v4
    v_min_u32 v7, 27, v1
    s_and_b32 s15, s14, 3
    s_mul_i32 s15, s15, 112
    s_mul_i32 s16, s12, 28
    s_add_u32 s15, s15, s16
    v_add_u32 v7, s15, v7
    s_or_b32 s15, s2, s12
    s_cmp_lg_u32 s15, 0
    s_cbranch_scc1 H_NOPUB
    s_mov_b32 s88, s96
    s_and_b32 s89, s97, 0xffff
    s_mov_b32 s90, 256
    s_mov_b32 s91, 0x00020000
    s_memrealtime s[92:93]
    v_mov_b32 v4, 0
    s_waitcnt lgkmcnt(0)
    s_or_b32 s92, s92, 1
    v_mov_b32 v5, s92
    buffer_store_dword v5, v4, s[88:91], 0 offen sc0 sc1
H_NOPUB:
    s_mov_b32 s85, 0
    s_lshl_b32 s17, s85, 3
    s_lshr_b32 s37, s18, s17
    s_cmp_ge_u32 s85, 4
    s_cselect_b32 s37, 3, s37
    s_and_b32 s38, s37, 3
    s_bfe_u32 s39, s37, 0x60002
    s_cmp_eq_u32 s38, 2
    s_cselect_b32 s44, s58, s54
    s_cselect_b32 s45, s59, s55
    s_mov_b32 s20, 21504
    s_cselect_b32 s20, 28672, s20
    s_mov_b32 s46, 1204224
    s_cselect_b32 s46, 1605632, s46
    s_cselect_b64 vcc, -1, 0
    s_and_b32 s45, s45, 0xffff
    s_mov_b32 s47, 0x00020000
    s_cmp_eq_u32 s38, 3
    s_cselect_b32 s46, 0, s46
    s_lshl_b32 s21, s20, 2
    v_cndmask_b32 v6, v15, v16, vcc
    s_lshr_b32 s17, s20, 3
    v_mul_lo_u32 v3, v7, s17
    s_lshl_b32 s17, s39, 7
    buffer_load_dword v24, v3, s[44:47], s17 offen
    s_waitcnt vmcnt(9)
    s_barrier
    s_add_u32 s85, s84, 12288
    s_mov_b32 m0, s85
    s_add_u32 s85, s23, 384
    buffer_load_dwordx4 v20, s[40:43], s85 offen lds
    s_add_u32 s85, s84, 13312
    s_mov_b32 m0, s85
    s_add_u32 s85, s23, 384
    buffer_load_dwordx4 v21, s[40:43], s85 offen lds
    s_add_u32 s85, s84, 14336
    s_mov_b32 m0, s85
    s_add_u32 s85, s23, 384
    buffer_load_dwordx4 v22, s[40:43], s85 offen lds
    s_add_u32 s85, s84, 15360
    s_mov_b32 m0, s85
    s_add_u32 s85, s23, 384
    buffer_load_dwordx4 v23, s[40:43], s85 offen lds
    s_waitcnt vmcnt(9)
    s_barrier
    s_add_u32 s85, s84, 16384
    s_mov_b32 m0, s85
    s_add_u32 s85, s23, 512
    buffer_load_dwordx4 v20, s[40:43], s85 offen lds
    s_add_u32 s85, s84, 17408
    s_mov_b32 m0, s85
    s_add_u32 s85, s23, 512
    buffer_load_dwordx4 v21, s[40:43], s85 offen lds
    s_add_u32 s85, s84, 18432
    s_mov_b32 m0, s85
    s_add_u32 s85, s23, 512
    buffer_load_dwordx4 v22, s[40:43], s85 offen lds
    s_add_u32 s85, s84, 19456
    s_mov_b32 m0, s85
    s_add_u32 s85, s23, 512
    buffer_load_dwordx4 v23, s[40:43], s85 offen lds
    s_waitcnt vmcnt(9)
    s_barrier
    s_add_u32 s85, s84, 20480
    s_mov_b32 m0, s85
    s_add_u32 s85, s23, 640
    buffer_load_dwordx4 v20, s[40:43], s85 offen lds
    s_add_u32 s85, s84, 21504
    s_mov_b32 m0, s85
    s_add_u32 s85, s23, 640
    buffer_load_dwordx4 v21, s[40:43], s85 offen lds
    s_add_u32 s85, s84, 22528
    s_mov_b32 m0, s85
    s_add_u32 s85, s23, 640
    buffer_load_dwordx4 v22, s[40:43], s85 offen lds
    s_add_u32 s85, s84, 23552
    s_mov_b32 m0, s85
    s_add_u32 s85, s23, 640
    buffer_load_dwordx4 v23, s[40:43], s85 offen lds
    s_waitcnt vmcnt(8)
    s_barrier
    s_lshl_b32 s17, s33, 3
    s_lshr_b32 s37, s18, s17
    s_cmp_ge_u32 s33, 4
    s_cselect_b32 s37, 3, s37
    s_and_b32 s38, s37, 3
    s_bfe_u32 s39, s37, 0x60002
    s_cmp_eq_u32 s38, 2
    s_cselect_b32 s44, s58, s54
    s_cselect_b32 s45, s59, s55
    s_mov_b32 s20, 21504
    s_cselect_b32 s20, 28672, s20
    s_mov_b32 s46, 1204224
    s_cselect_b32 s46, 1605632, s46
    s_cselect_b64 vcc, -1, 0
    s_and_b32 s45, s45, 0xffff
    s_mov_b32 s47, 0x00020000
    s_cmp_eq_u32 s38, 3
    s_cselect_b32 s46, 0, s46
    s_lshl_b32 s21, s20, 2
    v_cndmask_b32 v6, v15, v16, vcc
    s_mul_i32 s30, s12, s20
    s_lshl_b32 s17, s39, 7
    s_add_u32 s30, s30, s17
    s_and_b32 s17, s33, 1
    s_mul_i32 s29, s17, 57344
    s_lshl_b32 s17, s12, 10
    s_add_u32 s29, s29, s17
    s_mov_b32 m0, s29
    s_add_u32 s33, s33, 1
    buffer_load_dwordx4 v6, s[44:47], s30 offen lds
    s_add_u32 m0, m0, 4096
    s_add_u32 s30, s30, s21
    buffer_load_dwordx4 v6, s[44:47], s30 offen lds
    s_add_u32 m0, m0, 4096
    s_add_u32 s30, s30, s21
    buffer_load_dwordx4 v6, s[44:47], s30 offen lds
    s_add_u32 m0, m0, 4096
    s_add_u32 s30, s30, s21
    buffer_load_dwordx4 v6, s[44:47], s30 offen lds
    s_add_u32 m0, m0, 4096
    s_add_u32 s30, s30, s21
    buffer_load_dwordx4 v6, s[44:47], s30 offen lds
    s_add_u32 m0, m0, 4096
    s_add_u32 s30, s30, s21
    buffer_load_dwordx4 v6, s[44:47], s30 offen lds
    s_add_u32 m0, m0, 4096
    s_add_u32 s30, s30, s21
    buffer_load_dwordx4 v6, s[44:47], s30 offen lds
    s_add_u32 m0, m0, 4096
    s_add_u32 s30, s30, s21
    s_mov_b32 s29, m0
    s_waitcnt vmcnt(11)
    s_barrier
    s_mov_b32 m0, s29
    s_nop 0
    buffer_load_dwordx4 v6, s[44:47], s30 offen lds
    s_add_u32 m0, m0, 4096
    s_add_u32 s30, s30, s21
    buffer_load_dwordx4 v6, s[44:47], s30 offen lds
    s_add_u32 m0, m0, 4096
    s_add_u32 s30, s30, s21
    buffer_load_dwordx4 v6, s[44:47], s30 offen lds
    s_add_u32 m0, m0, 4096
    s_add_u32 s30, s30, s21
    buffer_load_dwordx4 v6, s[44:47], s30 offen lds
    s_add_u32 m0, m0, 4096
    s_add_u32 s30, s30, s21
    buffer_load_dwordx4 v6, s[44:47], s30 offen lds
    s_add_u32 m0, m0, 4096
    s_add_u32 s30, s30, s21
    buffer_load_dwordx4 v6, s[44:47], s30 offen lds
    s_add_u32 m0, m0, 4096
    s_add_u32 s30, s30, s21
    buffer_load_dwordx4 v6, s[44:47], s30 offen lds
    s_add_u32 m0, m0, 4096
    s_add_u32 s30, s30, s21
    s_waitcnt vmcnt(14)
    s_barrier
    s_mov_b32 s85, 1
    s_lshl_b32 s17, s85, 3
    s_lshr_b32 s37, s18, s17
    s_cmp_ge_u32 s85, 4
    s_cselect_b32 s37, 3, s37
    s_and_b32 s38, s37, 3
    s_bfe_u32 s39, s37, 0x60002
    s_cmp_eq_u32 s38, 2
    s_cselect_b32 s44, s58, s54
    s_cselect_b32 s45, s59, s55
    s_mov_b32 s20, 21504
    s_cselect_b32 s20, 28672, s20
    s_mov_b32 s46, 1204224
    s_cselect_b32 s46, 1605632, s46
    s_cselect_b64 vcc, -1, 0
    s_and_b32 s45, s45, 0xffff
    s_mov_b32 s47, 0x00020000
    s_cmp_eq_u32 s38, 3
    s_cselect_b32 s46, 0, s46
    s_lshl_b32 s21, s20, 2
    v_cndmask_b32 v6, v15, v16, vcc
    s_lshr_b32 s17, s20, 3
    v_mul_lo_u32 v3, v7, s17
    s_lshl_b32 s17, s39, 7
    buffer_load_dword v25, v3, s[44:47], s17 offen
    s_mov_b32 s85, 2
    s_lshl_b32 s17, s85, 3
    s_lshr_b32 s37, s18, s17
    s_cmp_ge_u32 s85, 4
    s_cselect_b32 s37, 3, s37
    s_and_b32 s38, s37, 3
    s_bfe_u32 s39, s37, 0x60002
    s_cmp_eq_u32 s38, 2
    s_cselect_b32 s44, s58, s54
    s_cselect_b32 s45, s59, s55
    s_mov_b32 s20, 21504
    s_cselect_b32 s20, 28672, s20
    s_mov_b32 s46, 1204224
    s_cselect_b32 s46, 1605632, s46
    s_cselect_b64 vcc, -1, 0
    s_and_b32 s45, s45, 0xffff
    s_mov_b32 s47, 0x00020000
    s_cmp_eq_u32 s38, 3
    s_cselect_b32 s46, 0, s46
    s_lshl_b32 s21, s20, 2
    v_cndmask_b32 v6, v15, v16, vcc
    s_lshr_b32 s17, s20, 3
    v_mul_lo_u32 v3, v7, s17
    s_lshl_b32 s17, s39, 7
    buffer_load_dword v26, v3, s[44:47], s17 offen
    s_mov_b32 s85, 3
    s_lshl_b32 s17, s85, 3
    s_lshr_b32 s37, s18, s17
    s_cmp_ge_u32 s85, 4
    s_cselect_b32 s37, 3, s37
    s_and_b32 s38, s37, 3
    s_bfe_u32 s39, s37, 0x60002
    s_cmp_eq_u32 s38, 2
    s_cselect_b32 s44, s58, s54
    s_cselect_b32 s45, s59, s55
    s_mov_b32 s20, 21504
    s_cselect_b32 s20, 28672, s20
    s_mov_b32 s46, 1204224
    s_cselect_b32 s46, 1605632, s46
    s_cselect_b64 vcc, -1, 0
    s_and_b32 s45, s45, 0xffff
    s_mov_b32 s47, 0x00020000
    s_cmp_eq_u32 s38, 3
    s_cselect_b32 s46, 0, s46
    s_lshl_b32 s21, s20, 2
    v_cndmask_b32 v6, v15, v16, vcc
    s_lshr_b32 s17, s20, 3
    v_mul_lo_u32 v3, v7, s17
    s_lshl_b32 s17, s39, 7
    buffer_load_dword v27, v3, s[44:47], s17 offen
    s_lshl_b32 s15, s2, 2
    s_add_u32 s15, s15, s12
    s_cmp_lt_u32 s15, 784
    s_cselect_b32 s88, s56, s86
    s_cselect_b32 s89, s57, s87
    s_cselect_b32 s16, 0, 784
    s_mov_b32 s90, 401408
    s_cselect_b32 s90, 1605632, s90
    s_sub_u32 s15, s15, s16
    s_lshl_b32 s15, s15, 11
    s_and_b32 s89, s89, 0xffff
    s_mov_b32 s91, 0x00020000
    buffer_load_dwordx4 v[28:31], v2, s[88:91], s15 offen
    buffer_load_dwordx4 v[32:35], v2, s[88:91], s15 offen offset:1024
    s_mov_b32 s8, s4
    s_and_b32 s9, s5, 0xffff
    s_mov_b32 s10, 20971520
    s_mov_b32 s11, 0x00020000
    v_and_b32 v3, 31, v1
    v_lshlrev_b32 v9, 4, v3
    v_lshrrev_b32 v8, 5, v1
    s_mov_b32 s31, 3222493025
    s_mov_b32 s32, 3184710632
    v_mov_b32 v10, s31
    s_mov_b32 s35, 0xffff0000
    v_mov_b32 v12, 129536
    v_mov_b32 v13, 0x20000000
    s_lshl_b32 s15, s12, 12
    s_add_u32 s15, s15, 114688
    v_add_u32 v14, s15, v2
    s_cmp_lg_u32 s12, 0
    s_cbranch_scc1 H_NOZ
    v_lshlrev_b32 v3, 2, v1
    v_add_u32 v3, 157696, v3
    v_mov_b32 v4, 0
    ds_write_b32 v3, v4
H_NOZ:
    s_waitcnt vmcnt(5) lgkmcnt(0)
    s_barrier
    s_barrier
    s_lshl_b32 s17, s33, 3
    s_lshr_b32 s37, s18, s17
    s_cmp_ge_u32 s33, 4
    s_cselect_b32 s37, 3, s37
    s_and_b32 s38, s37, 3
    s_bfe_u32 s39, s37, 0x60002
    s_cmp_eq_u32 s38, 2
    s_cselect_b32 s44, s58, s54
    s_cselect_b32 s45, s59, s55
    s_mov_b32 s20, 21504
    s_cselect_b32 s20, 28672, s20
    s_mov_b32 s46, 1204224
    s_cselect_b32 s46, 1605632, s46
    s_cselect_b64 vcc, -1, 0
    s_and_b32 s45, s45, 0xffff
    s_mov_b32 s47, 0x00020000
    s_cmp_eq_u32 s38, 3
    s_cselect_b32 s46, 0, s46
    s_lshl_b32 s21, s20, 2
    v_cndmask_b32 v6, v15, v16, vcc
    s_mul_i32 s30, s12, s20
    s_lshl_b32 s17, s39, 7
    s_add_u32 s30, s30, s17
    s_and_b32 s17, s33, 1
    s_mul_i32 s29, s17, 57344
    s_lshl_b32 s17, s12, 10
    s_add_u32 s29, s29, s17
    s_mov_b32 m0, s29
    s_add_u32 s33, s33, 1
    buffer_load_dwordx4 v6, s[44:47], s30 offen lds
    s_add_u32 m0, m0, 4096
    s_add_u32 s30, s30, s21
    buffer_load_dwordx4 v6, s[44:47], s30 offen lds
    s_add_u32 m0, m0, 4096
    s_add_u32 s30, s30, s21
    buffer_load_dwordx4 v6, s[44:47], s30 offen lds
    s_add_u32 m0, m0, 4096
    s_add_u32 s30, s30, s21
    buffer_load_dwordx4 v6, s[44:47], s30 offen lds
    s_add_u32 m0, m0, 4096
    s_add_u32 s30, s30, s21
    buffer_load_dwordx4 v6, s[44:47], s30 offen lds
    s_add_u32 m0, m0, 4096
    s_add_u32 s30, s30, s21
    buffer_load_dwordx4 v6, s[44:47], s30 offen lds
    s_add_u32 m0, m0, 4096
    s_add_u32 s30, s30, s21
    buffer_load_dwordx4 v6, s[44:47], s30 offen lds
    s_add_u32 m0, m0, 4096
    s_add_u32 s30, s30, s21
    s_mov_b32 s29, m0
    s_mov_b32 m0, s29
    s_nop 0
    buffer_load_dwordx4 v6, s[44:47], s30 offen lds
    s_add_u32 m0, m0, 4096
    s_add_u32 s30, s30, s21
    buffer_load_dwordx4 v6, s[44:47], s30 offen lds
    s_add_u32 m0, m0, 4096
    s_add_u32 s30, s30, s21
    buffer_load_dwordx4 v6, s[44:47], s30 offen lds
    s_add_u32 m0, m0, 4096
    s_add_u32 s30, s30, s21
    buffer_load_dwordx4 v6, s[44:47], s30 offen lds
    s_add_u32 m0, m0, 4096
    s_add_u32 s30, s30, s21
    buffer_load_dwordx4 v6, s[44:47], s30 offen lds
    s_add_u32 m0, m0, 4096
    s_add_u32 s30, s30, s21
    buffer_load_dwordx4 v6, s[44:47], s30 offen lds
    s_add_u32 m0, m0, 4096
    s_add_u32 s30, s30, s21
    buffer_load_dwordx4 v6, s[44:47], s30 offen lds
    s_add_u32 m0, m0, 4096
    s_add_u32 s30, s30, s21
    v_mov_b32 v4, 0
    s_mov_b32 s88, s96
    s_and_b32 s89, s97, 0xffff
    s_mov_b32 s90, 256
    s_mov_b32 s91, 0x00020000
    s_mov_b32 s92, 0
TP:
    buffer_load_dword v5, v4, s[88:91], 0 offen sc0 sc1
    s_waitcnt vmcnt(0)
    v_readfirstlane_b32 s94, v5
    s_add_u32 s92, s92, 1
    s_cmp_gt_u32 s92, 0x20000
    s_cbranch_scc1 TP_G
    s_cmp_lg_u32 s94, 0
    s_cbranch_scc1 TP_G
    s_sleep 2
    s_branch TP
TP_G:
    v_mov_b32 v3, 157780
    ds_write_b32 v3, v5
    buffer_store_dwordx4 v[48:51], v13, s[8:11], 0 offen sc0 sc1
    buffer_store_dwordx4 v[48:51], v13, s[8:11], 0 offen sc0 sc1
    buffer_store_dwordx4 v[48:51], v13, s[8:11], 0 offen sc0 sc1
    buffer_store_dwordx4 v[48:51], v13, s[8:11], 0 offen sc0 sc1
    s_mov_b32 s22, 0
H_LOOP:
    s_add_u32 s16, s22, 1
    s_cmp_ge_u32 s16, s19
    s_cbranch_scc1 H_LASTE
    s_waitcnt vmcnt(11) lgkmcnt(0)
    s_barrier
    s_lshl_b32 s17, s33, 3
    s_lshr_b32 s37, s18, s17
    s_cmp_ge_u32 s33, 4
    s_cselect_b32 s37, 3, s37
    s_and_b32 s38, s37, 3
    s_bfe_u32 s39, s37, 0x60002
    s_cmp_eq_u32 s38, 2
    s_cselect_b32 s44, s58, s54
    s_cselect_b32 s45, s59, s55
    s_mov_b32 s20, 21504
    s_cselect_b32 s20, 28672, s20
    s_mov_b32 s46, 1204224
    s_cselect_b32 s46, 1605632, s46
    s_cselect_b64 vcc, -1, 0
    s_and_b32 s45, s45, 0xffff
    s_mov_b32 s47, 0x00020000
    s_cmp_eq_u32 s38, 3
    s_cselect_b32 s46, 0, s46
    s_lshl_b32 s21, s20, 2
    v_cndmask_b32 v6, v15, v16, vcc
    s_mul_i32 s30, s12, s20
    s_lshl_b32 s17, s39, 7
    s_add_u32 s30, s30, s17
    s_and_b32 s17, s33, 1
    s_mul_i32 s29, s17, 57344
    s_lshl_b32 s17, s12, 10
    s_add_u32 s29, s29, s17
    s_mov_b32 m0, s29
    s_add_u32 s33, s33, 1
    buffer_load_dwordx4 v6, s[44:47], s30 offen lds
    s_add_u32 m0, m0, 4096
    s_add_u32 s30, s30, s21
    buffer_load_dwordx4 v6, s[44:47], s30 offen lds
    s_add_u32 m0, m0, 4096
    s_add_u32 s30, s30, s21
    buffer_load_dwordx4 v6, s[44:47], s30 offen lds
    s_add_u32 m0, m0, 4096
    s_add_u32 s30, s30, s21
    buffer_load_dwordx4 v6, s[44:47], s30 offen lds
    s_add_u32 m0, m0, 4096
    s_add_u32 s30, s30, s21
    buffer_load_dwordx4 v6, s[44:47], s30 offen lds
    s_add_u32 m0, m0, 4096
    s_add_u32 s30, s30, s21
    buffer_load_dwordx4 v6, s[44:47], s30 offen lds
    s_add_u32 m0, m0, 4096
    s_add_u32 s30, s30, s21
    buffer_load_dwordx4 v6, s[44:47], s30 offen lds
    s_add_u32 m0, m0, 4096
    s_add_u32 s30, s30, s21
    s_mov_b32 s29, m0
    ds_read_b128 v[48:51], v14 offset:0
    ds_read_b128 v[52:55], v14 offset:1024
    s_lshr_b32 s85, s22, 1
    s_lshl_b32 s17, s85, 3
    s_lshr_b32 s37, s18, s17
    s_cmp_ge_u32 s85, 4
    s_cselect_b32 s37, 3, s37
    s_and_b32 s62, s37, 3
    s_bfe_u32 s28, s37, 0x60002
    s_and_b32 s63, s22, 1
    s_and_b32 s17, s13, 1
    s_cmp_eq_u32 s22, 6
    s_cselect_b32 s63, s17, s63
    s_lshl_b32 s15, s36, 1
    s_cmp_lg_u32 s15, s22
    s_cbranch_scc1 H_NOQ
    s_waitcnt vmcnt(7)
    v_mov_b32 v3, 157824
    v_mov_b32 v4, 1
    s_mov_b64 exec, 1
    ds_add_rtn_u32 v5, v3, v4
    s_waitcnt lgkmcnt(0)
    v_readfirstlane_b32 s95, v5
    s_nop 3
    s_cmp_lg_u32 s95, 3
    s_cbranch_scc1 PUB_Q
    s_lshl_b32 s95, s13, 4
    s_add_u32 s95, s95, s14
    s_lshl_b32 s95, s95, 7
    s_add_u32 s95, s95, 19922944
    v_mov_b32 v4, s94
    v_mov_b32 v3, 0
    buffer_store_dword v4, v3, s[8:11], s95 offen sc0 sc1
PUB_Q:
    s_mov_b64 exec, -1
H_NOQ:
    s_cmp_lg_u32 s22, 4
    s_cbranch_scc1 H_NOE
    s_cmp_lt_u32 s13, 5
    s_cbranch_scc1 H_NOE
    s_waitcnt vmcnt(7)
    v_mov_b32 v3, 157832
    v_mov_b32 v4, 1
    s_mov_b64 exec, 1
    ds_add_rtn_u32 v5, v3, v4
    s_waitcnt lgkmcnt(0)
    v_readfirstlane_b32 s95, v5
    s_nop 3
    s_cmp_lg_u32 s95, 3
    s_cbranch_scc1 PUB_E
    s_lshl_b32 s95, s13, 4
    s_add_u32 s95, s95, s14
    s_lshl_b32 s95, s95, 7
    s_add_u32 s95, s95, 19988480
    v_mov_b32 v4, s94
    v_mov_b32 v3, 0
    buffer_store_dword v4, v3, s[8:11], s95 offen sc0 sc1
PUB_E:
    s_mov_b64 exec, -1
H_NOE:
    s_waitcnt lgkmcnt(0)
    s_cmp_eq_u32 s62, 2
    s_cbranch_scc1 EP1_M
    s_cmp_eq_u32 s62, 1
    s_cbranch_scc1 EP1_V
    s_branch EP1_X
EP1_V:
    s_branch EP1_X
EP1_M:
    v_lshlrev_b32 v32, 16, v48
    v_and_b32 v33, s35, v48
    v_lshlrev_b32 v34, 16, v49
    v_and_b32 v35, s35, v49
    v_mul_f32 v56, v32, v32
    v_mul_f32 v57, v33, v33
    v_mul_f32 v58, v34, v34
    v_mul_f32 v59, v35, v35
    v_fma_f32 v56, v56, s32, v10
    v_fma_f32 v57, v57, s32, v10
    v_fma_f32 v58, v58, s32, v10
    v_fma_f32 v59, v59, s32, v10
    v_mul_f32 v56, v56, v32
    v_mul_f32 v57, v57, v33
    v_mul_f32 v58, v58, v34
    v_mul_f32 v59, v59, v35
    v_exp_f32 v56, v56
    v_exp_f32 v57, v57
    v_exp_f32 v58, v58
    v_exp_f32 v59, v59
    v_add_f32 v56, 1.0, v56
    v_add_f32 v57, 1.0, v57
    v_add_f32 v58, 1.0, v58
    v_add_f32 v59, 1.0, v59
    v_rcp_f32 v56, v56
    v_rcp_f32 v57, v57
    v_rcp_f32 v58, v58
    v_rcp_f32 v59, v59
    v_mul_f32 v32, v32, v56
    v_mul_f32 v33, v33, v57
    v_mul_f32 v34, v34, v58
    v_mul_f32 v35, v35, v59
    v_cvt_pk_bf16_f32 v48, v32, v33
    v_cvt_pk_bf16_f32 v49, v34, v35
    v_lshlrev_b32 v36, 16, v50
    v_and_b32 v37, s35, v50
    v_lshlrev_b32 v38, 16, v51
    v_and_b32 v39, s35, v51
    v_mul_f32 v60, v36, v36
    v_mul_f32 v61, v37, v37
    v_mul_f32 v62, v38, v38
    v_mul_f32 v63, v39, v39
    v_fma_f32 v60, v60, s32, v10
    v_fma_f32 v61, v61, s32, v10
    v_fma_f32 v62, v62, s32, v10
    v_fma_f32 v63, v63, s32, v10
    v_mul_f32 v60, v60, v36
    v_mul_f32 v61, v61, v37
    v_mul_f32 v62, v62, v38
    v_mul_f32 v63, v63, v39
    v_exp_f32 v60, v60
    v_exp_f32 v61, v61
    v_exp_f32 v62, v62
    v_exp_f32 v63, v63
    v_add_f32 v60, 1.0, v60
    v_add_f32 v61, 1.0, v61
    v_add_f32 v62, 1.0, v62
    v_add_f32 v63, 1.0, v63
    v_rcp_f32 v60, v60
    v_rcp_f32 v61, v61
    v_rcp_f32 v62, v62
    v_rcp_f32 v63, v63
    v_mul_f32 v36, v36, v60
    v_mul_f32 v37, v37, v61
    v_mul_f32 v38, v38, v62
    v_mul_f32 v39, v39, v63
    v_cvt_pk_bf16_f32 v50, v36, v37
    v_cvt_pk_bf16_f32 v51, v38, v39
EP1_X:
    s_add_u32 s16, s22, 2
    s_cmp_ge_u32 s16, s19
    s_cbranch_scc1 H_LASTO
    s_waitcnt vmcnt(11)
    s_barrier
    s_mov_b32 m0, s29
    s_nop 0
    buffer_load_dwordx4 v6, s[44:47], s30 offen lds
    s_add_u32 m0, m0, 4096
    s_add_u32 s30, s30, s21
    buffer_load_dwordx4 v6, s[44:47], s30 offen lds
    s_add_u32 m0, m0, 4096
    s_add_u32 s30, s30, s21
    buffer_load_dwordx4 v6, s[44:47], s30 offen lds
    s_add_u32 m0, m0, 4096
    s_add_u32 s30, s30, s21
    buffer_load_dwordx4 v6, s[44:47], s30 offen lds
    s_add_u32 m0, m0, 4096
    s_add_u32 s30, s30, s21
    buffer_load_dwordx4 v6, s[44:47], s30 offen lds
    s_add_u32 m0, m0, 4096
    s_add_u32 s30, s30, s21
    buffer_load_dwordx4 v6, s[44:47], s30 offen lds
    s_add_u32 m0, m0, 4096
    s_add_u32 s30, s30, s21
    buffer_load_dwordx4 v6, s[44:47], s30 offen lds
    s_add_u32 m0, m0, 4096
    s_add_u32 s30, s30, s21
    s_cmp_eq_u32 s62, 2
    s_cbranch_scc1 EP2_M
    s_cmp_eq_u32 s62, 1
    s_cbranch_scc1 EP2_V
    s_cmp_ge_u32 s28, 7
    s_cselect_b32 s16, 7, 0
    s_mov_b32 s26, 0
    s_cselect_b32 s26, 2097152, s26
    s_mov_b32 s15, 0
    s_cselect_b32 s15, 0x3f803f80, s15
    v_mov_b32 v11, s15
    s_sub_u32 s16, s28, s16
    s_lshl_b32 s15, s25, 11
    s_add_u32 s26, s26, s15
    s_cmp_eq_u32 s62, 3
    s_cselect_b32 s26, 0x40000000, s26
    s_lshl_b32 s16, s16, 3
    s_lshl_b32 s15, s63, 2
    s_add_u32 s16, s16, s15
    v_add_u32 v5, s16, v8
    v_permlane32_swap_b32 v48, v50
    v_permlane32_swap_b32 v49, v51
    v_permlane32_swap_b32 v52, v54
    v_permlane32_swap_b32 v53, v55
    v_add_u32 v60, 0, v5
    v_mul_u32_u24 v3, 37, v60
    v_lshrrev_b32 v3, 8, v3
    v_mul_u32_u24 v4, 7, v3
    v_sub_u32 v4, v60, v4
    v_lshl_add_u32 v58, v3, 18, v9
    v_cmp_lt_u32 vcc, 3, v4
    v_mov_b32 v64, v11
    s_nop 0
    v_cndmask_b32 v60, 0, v12, vcc
    v_lshl_add_u32 v56, v4, 9, v58
    v_add_u32 v56, v56, v60
    v_cmp_eq_u32 vcc, 3, v4
    v_mov_b32 v65, v11
    v_mov_b32 v66, v50
    v_mov_b32 v67, v51
    v_cndmask_b32 v50, v50, v11, vcc
    v_cndmask_b32 v51, v51, v11, vcc
    v_add_u32 v58, 0x20000, v58
    v_cndmask_b32 v58, v13, v58, vcc
    v_add_u32 v60, 2, v5
    v_mul_u32_u24 v3, 37, v60
    v_lshrrev_b32 v3, 8, v3
    v_mul_u32_u24 v4, 7, v3
    v_sub_u32 v4, v60, v4
    v_lshl_add_u32 v59, v3, 18, v9
    v_cmp_lt_u32 vcc, 3, v4
    v_mov_b32 v68, v11
    s_nop 0
    v_cndmask_b32 v60, 0, v12, vcc
    v_lshl_add_u32 v57, v4, 9, v59
    v_add_u32 v57, v57, v60
    v_cmp_eq_u32 vcc, 3, v4
    v_mov_b32 v69, v11
    v_mov_b32 v70, v54
    v_mov_b32 v71, v55
    v_cndmask_b32 v54, v54, v11, vcc
    v_cndmask_b32 v55, v55, v11, vcc
    v_add_u32 v59, 0x20000, v59
    v_cndmask_b32 v59, v13, v59, vcc
    buffer_store_dwordx4 v[48:51], v56, s[8:11], s26 offen sc0 sc1
    buffer_store_dwordx4 v[64:67], v58, s[8:11], s26 offen sc0 sc1
    buffer_store_dwordx4 v[52:55], v57, s[8:11], s26 offen sc0 sc1
    buffer_store_dwordx4 v[68:71], v59, s[8:11], s26 offen sc0 sc1
    s_branch EP2_X
EP2_V:
    s_sub_u32 s16, s28, 14
    s_lshl_b32 s16, s16, 6
    s_lshl_b32 s15, s63, 5
    s_add_u32 s16, s16, s15
    s_lshl_b32 s15, s25, 11
    s_add_u32 s26, s15, 4194304
    v_lshrrev_b32 v3, 4, v9
    v_add_u32 v3, s16, v3
    v_mul_u32_u24 v4, 2341, v3
    v_lshrrev_b32 v4, 16, v4
    v_mul_u32_u24 v5, 28, v4
    v_sub_u32 v3, v3, v5
    v_lshlrev_b32 v3, 4, v3
    v_lshlrev_b32 v4, 17, v4
    v_add_u32 v3, v3, v4
    v_lshlrev_b32 v4, 9, v8
    v_add_u32 v56, v3, v4
    buffer_store_dwordx4 v[48:51], v56, s[8:11], s26 offen sc0 sc1
    buffer_store_dwordx4 v[52:55], v56, s[8:11], s26 offen offset:1024 sc0 sc1
    s_branch EP2_X
EP2_M:
    v_lshlrev_b32 v40, 16, v52
    v_and_b32 v41, s35, v52
    v_lshlrev_b32 v42, 16, v53
    v_and_b32 v43, s35, v53
    v_mul_f32 v56, v40, v40
    v_mul_f32 v57, v41, v41
    v_mul_f32 v58, v42, v42
    v_mul_f32 v59, v43, v43
    v_fma_f32 v56, v56, s32, v10
    v_fma_f32 v57, v57, s32, v10
    v_fma_f32 v58, v58, s32, v10
    v_fma_f32 v59, v59, s32, v10
    v_mul_f32 v56, v56, v40
    v_mul_f32 v57, v57, v41
    v_mul_f32 v58, v58, v42
    v_mul_f32 v59, v59, v43
    v_exp_f32 v56, v56
    v_exp_f32 v57, v57
    v_exp_f32 v58, v58
    v_exp_f32 v59, v59
    v_add_f32 v56, 1.0, v56
    v_add_f32 v57, 1.0, v57
    v_add_f32 v58, 1.0, v58
    v_add_f32 v59, 1.0, v59
    v_rcp_f32 v56, v56
    v_rcp_f32 v57, v57
    v_rcp_f32 v58, v58
    v_rcp_f32 v59, v59
    v_mul_f32 v40, v40, v56
    v_mul_f32 v41, v41, v57
    v_mul_f32 v42, v42, v58
    v_mul_f32 v43, v43, v59
    v_cvt_pk_bf16_f32 v52, v40, v41
    v_cvt_pk_bf16_f32 v53, v42, v43
    v_lshlrev_b32 v44, 16, v54
    v_and_b32 v45, s35, v54
    v_lshlrev_b32 v46, 16, v55
    v_and_b32 v47, s35, v55
    v_mul_f32 v60, v44, v44
    v_mul_f32 v61, v45, v45
    v_mul_f32 v62, v46, v46
    v_mul_f32 v63, v47, v47
    v_fma_f32 v60, v60, s32, v10
    v_fma_f32 v61, v61, s32, v10
    v_fma_f32 v62, v62, s32, v10
    v_fma_f32 v63, v63, s32, v10
    v_mul_f32 v60, v60, v44
    v_mul_f32 v61, v61, v45
    v_mul_f32 v62, v62, v46
    v_mul_f32 v63, v63, v47
    v_exp_f32 v60, v60
    v_exp_f32 v61, v61
    v_exp_f32 v62, v62
    v_exp_f32 v63, v63
    v_add_f32 v60, 1.0, v60
    v_add_f32 v61, 1.0, v61
    v_add_f32 v62, 1.0, v62
    v_add_f32 v63, 1.0, v63
    v_rcp_f32 v60, v60
    v_rcp_f32 v61, v61
    v_rcp_f32 v62, v62
    v_rcp_f32 v63, v63
    v_mul_f32 v44, v44, v60
    v_mul_f32 v45, v45, v61
    v_mul_f32 v46, v46, v62
    v_mul_f32 v47, v47, v63
    v_cvt_pk_bf16_f32 v54, v44, v45
    v_cvt_pk_bf16_f32 v55, v46, v47
    s_lshl_b32 s16, s28, 1
    s_add_u32 s16, s16, s63
    s_lshl_b32 s16, s16, 11
    s_mul_i32 s26, s25, 147456
    s_add_u32 s26, s26, s16
    s_add_u32 s26, s26, 6291456
    buffer_store_dwordx4 v[48:51], v2, s[8:11], s26 offen sc0 sc1
    buffer_store_dwordx4 v[52:55], v2, s[8:11], s26 offen offset:1024 sc0 sc1
EP2_X:
    s_add_u32 s22, s22, 1
    ds_read_b128 v[48:51], v14 offset:2048
    ds_read_b128 v[52:55], v14 offset:3072
    s_lshr_b32 s85, s22, 1
    s_lshl_b32 s17, s85, 3
    s_lshr_b32 s37, s18, s17
    s_cmp_ge_u32 s85, 4
    s_cselect_b32 s37, 3, s37
    s_and_b32 s62, s37, 3
    s_bfe_u32 s28, s37, 0x60002
    s_and_b32 s63, s22, 1
    s_and_b32 s17, s13, 1
    s_cmp_eq_u32 s22, 6
    s_cselect_b32 s63, s17, s63
    s_waitcnt lgkmcnt(0)
    s_cmp_eq_u32 s62, 2
    s_cbranch_scc1 EP3_M
    s_cmp_eq_u32 s62, 1
    s_cbranch_scc1 EP3_V
    s_cmp_ge_u32 s28, 7
    s_cselect_b32 s16, 7, 0
    s_mov_b32 s26, 0
    s_cselect_b32 s26, 2097152, s26
    s_mov_b32 s15, 0
    s_cselect_b32 s15, 0x3f803f80, s15
    v_mov_b32 v11, s15
    s_sub_u32 s16, s28, s16
    s_lshl_b32 s15, s25, 11
    s_add_u32 s26, s26, s15
    s_cmp_eq_u32 s62, 3
    s_cselect_b32 s26, 0x40000000, s26
    s_lshl_b32 s16, s16, 3
    s_lshl_b32 s15, s63, 2
    s_add_u32 s16, s16, s15
    v_add_u32 v5, s16, v8
    v_permlane32_swap_b32 v48, v50
    v_permlane32_swap_b32 v49, v51
    v_permlane32_swap_b32 v52, v54
    v_permlane32_swap_b32 v53, v55
    v_add_u32 v60, 0, v5
    v_mul_u32_u24 v3, 37, v60
    v_lshrrev_b32 v3, 8, v3
    v_mul_u32_u24 v4, 7, v3
    v_sub_u32 v4, v60, v4
    v_lshl_add_u32 v58, v3, 18, v9
    v_cmp_lt_u32 vcc, 3, v4
    v_mov_b32 v64, v11
    s_nop 0
    v_cndmask_b32 v60, 0, v12, vcc
    v_lshl_add_u32 v56, v4, 9, v58
    v_add_u32 v56, v56, v60
    v_cmp_eq_u32 vcc, 3, v4
    v_mov_b32 v65, v11
    v_mov_b32 v66, v50
    v_mov_b32 v67, v51
    v_cndmask_b32 v50, v50, v11, vcc
    v_cndmask_b32 v51, v51, v11, vcc
    v_add_u32 v58, 0x20000, v58
    v_cndmask_b32 v58, v13, v58, vcc
    v_add_u32 v60, 2, v5
    v_mul_u32_u24 v3, 37, v60
    v_lshrrev_b32 v3, 8, v3
    v_mul_u32_u24 v4, 7, v3
    v_sub_u32 v4, v60, v4
    v_lshl_add_u32 v59, v3, 18, v9
    v_cmp_lt_u32 vcc, 3, v4
    v_mov_b32 v68, v11
    s_nop 0
    v_cndmask_b32 v60, 0, v12, vcc
    v_lshl_add_u32 v57, v4, 9, v59
    v_add_u32 v57, v57, v60
    v_cmp_eq_u32 vcc, 3, v4
    v_mov_b32 v69, v11
    v_mov_b32 v70, v54
    v_mov_b32 v71, v55
    v_cndmask_b32 v54, v54, v11, vcc
    v_cndmask_b32 v55, v55, v11, vcc
    v_add_u32 v59, 0x20000, v59
    v_cndmask_b32 v59, v13, v59, vcc
    buffer_store_dwordx4 v[48:51], v56, s[8:11], s26 offen sc0 sc1
    buffer_store_dwordx4 v[64:67], v58, s[8:11], s26 offen sc0 sc1
    buffer_store_dwordx4 v[52:55], v57, s[8:11], s26 offen sc0 sc1
    buffer_store_dwordx4 v[68:71], v59, s[8:11], s26 offen sc0 sc1
    s_branch EP3_X
EP3_V:
    s_sub_u32 s16, s28, 14
    s_lshl_b32 s16, s16, 6
    s_lshl_b32 s15, s63, 5
    s_add_u32 s16, s16, s15
    s_lshl_b32 s15, s25, 11
    s_add_u32 s26, s15, 4194304
    v_lshrrev_b32 v3, 4, v9
    v_add_u32 v3, s16, v3
    v_mul_u32_u24 v4, 2341, v3
    v_lshrrev_b32 v4, 16, v4
    v_mul_u32_u24 v5, 28, v4
    v_sub_u32 v3, v3, v5
    v_lshlrev_b32 v3, 4, v3
    v_lshlrev_b32 v4, 17, v4
    v_add_u32 v3, v3, v4
    v_lshlrev_b32 v4, 9, v8
    v_add_u32 v56, v3, v4
    buffer_store_dwordx4 v[48:51], v56, s[8:11], s26 offen sc0 sc1
    buffer_store_dwordx4 v[52:55], v56, s[8:11], s26 offen offset:1024 sc0 sc1
    s_branch EP3_X
EP3_M:
    v_lshlrev_b32 v32, 16, v48
    v_and_b32 v33, s35, v48
    v_lshlrev_b32 v34, 16, v49
    v_and_b32 v35, s35, v49
    v_mul_f32 v56, v32, v32
    v_mul_f32 v57, v33, v33
    v_mul_f32 v58, v34, v34
    v_mul_f32 v59, v35, v35
    v_fma_f32 v56, v56, s32, v10
    v_fma_f32 v57, v57, s32, v10
    v_fma_f32 v58, v58, s32, v10
    v_fma_f32 v59, v59, s32, v10
    v_mul_f32 v56, v56, v32
    v_mul_f32 v57, v57, v33
    v_mul_f32 v58, v58, v34
    v_mul_f32 v59, v59, v35
    v_exp_f32 v56, v56
    v_exp_f32 v57, v57
    v_exp_f32 v58, v58
    v_exp_f32 v59, v59
    v_add_f32 v56, 1.0, v56
    v_add_f32 v57, 1.0, v57
    v_add_f32 v58, 1.0, v58
    v_add_f32 v59, 1.0, v59
    v_rcp_f32 v56, v56
    v_rcp_f32 v57, v57
    v_rcp_f32 v58, v58
    v_rcp_f32 v59, v59
    v_mul_f32 v32, v32, v56
    v_mul_f32 v33, v33, v57
    v_mul_f32 v34, v34, v58
    v_mul_f32 v35, v35, v59
    v_cvt_pk_bf16_f32 v48, v32, v33
    v_cvt_pk_bf16_f32 v49, v34, v35
    v_lshlrev_b32 v36, 16, v50
    v_and_b32 v37, s35, v50
    v_lshlrev_b32 v38, 16, v51
    v_and_b32 v39, s35, v51
    v_mul_f32 v60, v36, v36
    v_mul_f32 v61, v37, v37
    v_mul_f32 v62, v38, v38
    v_mul_f32 v63, v39, v39
    v_fma_f32 v60, v60, s32, v10
    v_fma_f32 v61, v61, s32, v10
    v_fma_f32 v62, v62, s32, v10
    v_fma_f32 v63, v63, s32, v10
    v_mul_f32 v60, v60, v36
    v_mul_f32 v61, v61, v37
    v_mul_f32 v62, v62, v38
    v_mul_f32 v63, v63, v39
    v_exp_f32 v60, v60
    v_exp_f32 v61, v61
    v_exp_f32 v62, v62
    v_exp_f32 v63, v63
    v_add_f32 v60, 1.0, v60
    v_add_f32 v61, 1.0, v61
    v_add_f32 v62, 1.0, v62
    v_add_f32 v63, 1.0, v63
    v_rcp_f32 v60, v60
    v_rcp_f32 v61, v61
    v_rcp_f32 v62, v62
    v_rcp_f32 v63, v63
    v_mul_f32 v36, v36, v60
    v_mul_f32 v37, v37, v61
    v_mul_f32 v38, v38, v62
    v_mul_f32 v39, v39, v63
    v_cvt_pk_bf16_f32 v50, v36, v37
    v_cvt_pk_bf16_f32 v51, v38, v39
    v_lshlrev_b32 v40, 16, v52
    v_and_b32 v41, s35, v52
    v_lshlrev_b32 v42, 16, v53
    v_and_b32 v43, s35, v53
    v_mul_f32 v56, v40, v40
    v_mul_f32 v57, v41, v41
    v_mul_f32 v58, v42, v42
    v_mul_f32 v59, v43, v43
    v_fma_f32 v56, v56, s32, v10
    v_fma_f32 v57, v57, s32, v10
    v_fma_f32 v58, v58, s32, v10
    v_fma_f32 v59, v59, s32, v10
    v_mul_f32 v56, v56, v40
    v_mul_f32 v57, v57, v41
    v_mul_f32 v58, v58, v42
    v_mul_f32 v59, v59, v43
    v_exp_f32 v56, v56
    v_exp_f32 v57, v57
    v_exp_f32 v58, v58
    v_exp_f32 v59, v59
    v_add_f32 v56, 1.0, v56
    v_add_f32 v57, 1.0, v57
    v_add_f32 v58, 1.0, v58
    v_add_f32 v59, 1.0, v59
    v_rcp_f32 v56, v56
    v_rcp_f32 v57, v57
    v_rcp_f32 v58, v58
    v_rcp_f32 v59, v59
    v_mul_f32 v40, v40, v56
    v_mul_f32 v41, v41, v57
    v_mul_f32 v42, v42, v58
    v_mul_f32 v43, v43, v59
    v_cvt_pk_bf16_f32 v52, v40, v41
    v_cvt_pk_bf16_f32 v53, v42, v43
    v_lshlrev_b32 v44, 16, v54
    v_and_b32 v45, s35, v54
    v_lshlrev_b32 v46, 16, v55
    v_and_b32 v47, s35, v55
    v_mul_f32 v60, v44, v44
    v_mul_f32 v61, v45, v45
    v_mul_f32 v62, v46, v46
    v_mul_f32 v63, v47, v47
    v_fma_f32 v60, v60, s32, v10
    v_fma_f32 v61, v61, s32, v10
    v_fma_f32 v62, v62, s32, v10
    v_fma_f32 v63, v63, s32, v10
    v_mul_f32 v60, v60, v44
    v_mul_f32 v61, v61, v45
    v_mul_f32 v62, v62, v46
    v_mul_f32 v63, v63, v47
    v_exp_f32 v60, v60
    v_exp_f32 v61, v61
    v_exp_f32 v62, v62
    v_exp_f32 v63, v63
    v_add_f32 v60, 1.0, v60
    v_add_f32 v61, 1.0, v61
    v_add_f32 v62, 1.0, v62
    v_add_f32 v63, 1.0, v63
    v_rcp_f32 v60, v60
    v_rcp_f32 v61, v61
    v_rcp_f32 v62, v62
    v_rcp_f32 v63, v63
    v_mul_f32 v44, v44, v60
    v_mul_f32 v45, v45, v61
    v_mul_f32 v46, v46, v62
    v_mul_f32 v47, v47, v63
    v_cvt_pk_bf16_f32 v54, v44, v45
    v_cvt_pk_bf16_f32 v55, v46, v47
    s_lshl_b32 s16, s28, 1
    s_add_u32 s16, s16, s63
    s_lshl_b32 s16, s16, 11
    s_mul_i32 s26, s25, 147456
    s_add_u32 s26, s26, s16
    s_add_u32 s26, s26, 6291456
    buffer_store_dwordx4 v[48:51], v2, s[8:11], s26 offen sc0 sc1
    buffer_store_dwordx4 v[52:55], v2, s[8:11], s26 offen offset:1024 sc0 sc1
EP3_X:
    s_add_u32 s22, s22, 1
    s_branch H_LOOP
H_LASTO:
    s_cmp_eq_u32 s62, 2
    s_cbranch_scc1 EP4_M
    s_cmp_eq_u32 s62, 1
    s_cbranch_scc1 EP4_V
    s_cmp_ge_u32 s28, 7
    s_cselect_b32 s16, 7, 0
    s_mov_b32 s26, 0
    s_cselect_b32 s26, 2097152, s26
    s_mov_b32 s15, 0
    s_cselect_b32 s15, 0x3f803f80, s15
    v_mov_b32 v11, s15
    s_sub_u32 s16, s28, s16
    s_lshl_b32 s15, s25, 11
    s_add_u32 s26, s26, s15
    s_cmp_eq_u32 s62, 3
    s_cselect_b32 s26, 0x40000000, s26
    s_lshl_b32 s16, s16, 3
    s_lshl_b32 s15, s63, 2
    s_add_u32 s16, s16, s15
    v_add_u32 v5, s16, v8
    v_permlane32_swap_b32 v48, v50
    v_permlane32_swap_b32 v49, v51
    v_permlane32_swap_b32 v52, v54
    v_permlane32_swap_b32 v53, v55
    v_add_u32 v60, 0, v5
    v_mul_u32_u24 v3, 37, v60
    v_lshrrev_b32 v3, 8, v3
    v_mul_u32_u24 v4, 7, v3
    v_sub_u32 v4, v60, v4
    v_lshl_add_u32 v58, v3, 18, v9
    v_cmp_lt_u32 vcc, 3, v4
    v_mov_b32 v64, v11
    s_nop 0
    v_cndmask_b32 v60, 0, v12, vcc
    v_lshl_add_u32 v56, v4, 9, v58
    v_add_u32 v56, v56, v60
    v_cmp_eq_u32 vcc, 3, v4
    v_mov_b32 v65, v11
    v_mov_b32 v66, v50
    v_mov_b32 v67, v51
    v_cndmask_b32 v50, v50, v11, vcc
    v_cndmask_b32 v51, v51, v11, vcc
    v_add_u32 v58, 0x20000, v58
    v_cndmask_b32 v58, v13, v58, vcc
    v_add_u32 v60, 2, v5
    v_mul_u32_u24 v3, 37, v60
    v_lshrrev_b32 v3, 8, v3
    v_mul_u32_u24 v4, 7, v3
    v_sub_u32 v4, v60, v4
    v_lshl_add_u32 v59, v3, 18, v9
    v_cmp_lt_u32 vcc, 3, v4
    v_mov_b32 v68, v11
    s_nop 0
    v_cndmask_b32 v60, 0, v12, vcc
    v_lshl_add_u32 v57, v4, 9, v59
    v_add_u32 v57, v57, v60
    v_cmp_eq_u32 vcc, 3, v4
    v_mov_b32 v69, v11
    v_mov_b32 v70, v54
    v_mov_b32 v71, v55
    v_cndmask_b32 v54, v54, v11, vcc
    v_cndmask_b32 v55, v55, v11, vcc
    v_add_u32 v59, 0x20000, v59
    v_cndmask_b32 v59, v13, v59, vcc
    buffer_store_dwordx4 v[48:51], v56, s[8:11], s26 offen sc0 sc1
    buffer_store_dwordx4 v[64:67], v58, s[8:11], s26 offen sc0 sc1
    buffer_store_dwordx4 v[52:55], v57, s[8:11], s26 offen sc0 sc1
    buffer_store_dwordx4 v[68:71], v59, s[8:11], s26 offen sc0 sc1
    s_branch EP4_X
EP4_V:
    s_sub_u32 s16, s28, 14
    s_lshl_b32 s16, s16, 6
    s_lshl_b32 s15, s63, 5
    s_add_u32 s16, s16, s15
    s_lshl_b32 s15, s25, 11
    s_add_u32 s26, s15, 4194304
    v_lshrrev_b32 v3, 4, v9
    v_add_u32 v3, s16, v3
    v_mul_u32_u24 v4, 2341, v3
    v_lshrrev_b32 v4, 16, v4
    v_mul_u32_u24 v5, 28, v4
    v_sub_u32 v3, v3, v5
    v_lshlrev_b32 v3, 4, v3
    v_lshlrev_b32 v4, 17, v4
    v_add_u32 v3, v3, v4
    v_lshlrev_b32 v4, 9, v8
    v_add_u32 v56, v3, v4
    buffer_store_dwordx4 v[48:51], v56, s[8:11], s26 offen sc0 sc1
    buffer_store_dwordx4 v[52:55], v56, s[8:11], s26 offen offset:1024 sc0 sc1
    s_branch EP4_X
EP4_M:
    v_lshlrev_b32 v40, 16, v52
    v_and_b32 v41, s35, v52
    v_lshlrev_b32 v42, 16, v53
    v_and_b32 v43, s35, v53
    v_mul_f32 v56, v40, v40
    v_mul_f32 v57, v41, v41
    v_mul_f32 v58, v42, v42
    v_mul_f32 v59, v43, v43
    v_fma_f32 v56, v56, s32, v10
    v_fma_f32 v57, v57, s32, v10
    v_fma_f32 v58, v58, s32, v10
    v_fma_f32 v59, v59, s32, v10
    v_mul_f32 v56, v56, v40
    v_mul_f32 v57, v57, v41
    v_mul_f32 v58, v58, v42
    v_mul_f32 v59, v59, v43
    v_exp_f32 v56, v56
    v_exp_f32 v57, v57
    v_exp_f32 v58, v58
    v_exp_f32 v59, v59
    v_add_f32 v56, 1.0, v56
    v_add_f32 v57, 1.0, v57
    v_add_f32 v58, 1.0, v58
    v_add_f32 v59, 1.0, v59
    v_rcp_f32 v56, v56
    v_rcp_f32 v57, v57
    v_rcp_f32 v58, v58
    v_rcp_f32 v59, v59
    v_mul_f32 v40, v40, v56
    v_mul_f32 v41, v41, v57
    v_mul_f32 v42, v42, v58
    v_mul_f32 v43, v43, v59
    v_cvt_pk_bf16_f32 v52, v40, v41
    v_cvt_pk_bf16_f32 v53, v42, v43
    v_lshlrev_b32 v44, 16, v54
    v_and_b32 v45, s35, v54
    v_lshlrev_b32 v46, 16, v55
    v_and_b32 v47, s35, v55
    v_mul_f32 v60, v44, v44
    v_mul_f32 v61, v45, v45
    v_mul_f32 v62, v46, v46
    v_mul_f32 v63, v47, v47
    v_fma_f32 v60, v60, s32, v10
    v_fma_f32 v61, v61, s32, v10
    v_fma_f32 v62, v62, s32, v10
    v_fma_f32 v63, v63, s32, v10
    v_mul_f32 v60, v60, v44
    v_mul_f32 v61, v61, v45
    v_mul_f32 v62, v62, v46
    v_mul_f32 v63, v63, v47
    v_exp_f32 v60, v60
    v_exp_f32 v61, v61
    v_exp_f32 v62, v62
    v_exp_f32 v63, v63
    v_add_f32 v60, 1.0, v60
    v_add_f32 v61, 1.0, v61
    v_add_f32 v62, 1.0, v62
    v_add_f32 v63, 1.0, v63
    v_rcp_f32 v60, v60
    v_rcp_f32 v61, v61
    v_rcp_f32 v62, v62
    v_rcp_f32 v63, v63
    v_mul_f32 v44, v44, v60
    v_mul_f32 v45, v45, v61
    v_mul_f32 v46, v46, v62
    v_mul_f32 v47, v47, v63
    v_cvt_pk_bf16_f32 v54, v44, v45
    v_cvt_pk_bf16_f32 v55, v46, v47
    s_lshl_b32 s16, s28, 1
    s_add_u32 s16, s16, s63
    s_lshl_b32 s16, s16, 11
    s_mul_i32 s26, s25, 147456
    s_add_u32 s26, s26, s16
    s_add_u32 s26, s26, 6291456
    buffer_store_dwordx4 v[48:51], v2, s[8:11], s26 offen sc0 sc1
    buffer_store_dwordx4 v[52:55], v2, s[8:11], s26 offen offset:1024 sc0 sc1
EP4_X:
    s_setprio 2
    s_lshl_b32 s15, s12, 2
    s_add_u32 s15, s15, 157840
    v_mov_b32 v3, s15
    s_mov_b32 s92, 0
XW1:
    ds_read_b32 v4, v3
    s_waitcnt lgkmcnt(0)
    v_readfirstlane_b32 s15, v4
    s_add_u32 s92, s92, 1
    s_cmp_gt_u32 s92, 0x80000
    s_cbranch_scc1 XW1_X
    s_cmp_eq_u32 s15, 0
    s_cbranch_scc1 XW1
XW1_X:
    s_add_u32 s22, s22, 1
    ds_read_b128 v[48:51], v14 offset:2048
    ds_read_b128 v[52:55], v14 offset:3072
    s_lshr_b32 s85, s22, 1
    s_lshl_b32 s17, s85, 3
    s_lshr_b32 s37, s18, s17
    s_cmp_ge_u32 s85, 4
    s_cselect_b32 s37, 3, s37
    s_and_b32 s62, s37, 3
    s_bfe_u32 s28, s37, 0x60002
    s_and_b32 s63, s22, 1
    s_and_b32 s17, s13, 1
    s_cmp_eq_u32 s22, 6
    s_cselect_b32 s63, s17, s63
    s_waitcnt lgkmcnt(0)
    s_cmp_eq_u32 s62, 2
    s_cbranch_scc1 EP5_M
    s_cmp_eq_u32 s62, 1
    s_cbranch_scc1 EP5_V
    s_cmp_ge_u32 s28, 7
    s_cselect_b32 s16, 7, 0
    s_mov_b32 s26, 0
    s_cselect_b32 s26, 2097152, s26
    s_mov_b32 s15, 0
    s_cselect_b32 s15, 0x3f803f80, s15
    v_mov_b32 v11, s15
    s_sub_u32 s16, s28, s16
    s_lshl_b32 s15, s25, 11
    s_add_u32 s26, s26, s15
    s_cmp_eq_u32 s62, 3
    s_cselect_b32 s26, 0x40000000, s26
    s_lshl_b32 s16, s16, 3
    s_lshl_b32 s15, s63, 2
    s_add_u32 s16, s16, s15
    v_add_u32 v5, s16, v8
    v_permlane32_swap_b32 v48, v50
    v_permlane32_swap_b32 v49, v51
    v_permlane32_swap_b32 v52, v54
    v_permlane32_swap_b32 v53, v55
    v_add_u32 v60, 0, v5
    v_mul_u32_u24 v3, 37, v60
    v_lshrrev_b32 v3, 8, v3
    v_mul_u32_u24 v4, 7, v3
    v_sub_u32 v4, v60, v4
    v_lshl_add_u32 v58, v3, 18, v9
    v_cmp_lt_u32 vcc, 3, v4
    v_mov_b32 v64, v11
    s_nop 0
    v_cndmask_b32 v60, 0, v12, vcc
    v_lshl_add_u32 v56, v4, 9, v58
    v_add_u32 v56, v56, v60
    v_cmp_eq_u32 vcc, 3, v4
    v_mov_b32 v65, v11
    v_mov_b32 v66, v50
    v_mov_b32 v67, v51
    v_cndmask_b32 v50, v50, v11, vcc
    v_cndmask_b32 v51, v51, v11, vcc
    v_add_u32 v58, 0x20000, v58
    v_cndmask_b32 v58, v13, v58, vcc
    v_add_u32 v60, 2, v5
    v_mul_u32_u24 v3, 37, v60
    v_lshrrev_b32 v3, 8, v3
    v_mul_u32_u24 v4, 7, v3
    v_sub_u32 v4, v60, v4
    v_lshl_add_u32 v59, v3, 18, v9
    v_cmp_lt_u32 vcc, 3, v4
    v_mov_b32 v68, v11
    s_nop 0
    v_cndmask_b32 v60, 0, v12, vcc
    v_lshl_add_u32 v57, v4, 9, v59
    v_add_u32 v57, v57, v60
    v_cmp_eq_u32 vcc, 3, v4
    v_mov_b32 v69, v11
    v_mov_b32 v70, v54
    v_mov_b32 v71, v55
    v_cndmask_b32 v54, v54, v11, vcc
    v_cndmask_b32 v55, v55, v11, vcc
    v_add_u32 v59, 0x20000, v59
    v_cndmask_b32 v59, v13, v59, vcc
    buffer_store_dwordx4 v[48:51], v56, s[8:11], s26 offen sc0 sc1
    buffer_store_dwordx4 v[64:67], v58, s[8:11], s26 offen sc0 sc1
    buffer_store_dwordx4 v[52:55], v57, s[8:11], s26 offen sc0 sc1
    buffer_store_dwordx4 v[68:71], v59, s[8:11], s26 offen sc0 sc1
    s_branch EP5_X
EP5_V:
    s_sub_u32 s16, s28, 14
    s_lshl_b32 s16, s16, 6
    s_lshl_b32 s15, s63, 5
    s_add_u32 s16, s16, s15
    s_lshl_b32 s15, s25, 11
    s_add_u32 s26, s15, 4194304
    v_lshrrev_b32 v3, 4, v9
    v_add_u32 v3, s16, v3
    v_mul_u32_u24 v4, 2341, v3
    v_lshrrev_b32 v4, 16, v4
    v_mul_u32_u24 v5, 28, v4
    v_sub_u32 v3, v3, v5
    v_lshlrev_b32 v3, 4, v3
    v_lshlrev_b32 v4, 17, v4
    v_add_u32 v3, v3, v4
    v_lshlrev_b32 v4, 9, v8
    v_add_u32 v56, v3, v4
    buffer_store_dwordx4 v[48:51], v56, s[8:11], s26 offen sc0 sc1
    buffer_store_dwordx4 v[52:55], v56, s[8:11], s26 offen offset:1024 sc0 sc1
    s_branch EP5_X
EP5_M:
    v_lshlrev_b32 v32, 16, v48
    v_and_b32 v33, s35, v48
    v_lshlrev_b32 v34, 16, v49
    v_and_b32 v35, s35, v49
    v_mul_f32 v56, v32, v32
    v_mul_f32 v57, v33, v33
    v_mul_f32 v58, v34, v34
    v_mul_f32 v59, v35, v35
    v_fma_f32 v56, v56, s32, v10
    v_fma_f32 v57, v57, s32, v10
    v_fma_f32 v58, v58, s32, v10
    v_fma_f32 v59, v59, s32, v10
    v_mul_f32 v56, v56, v32
    v_mul_f32 v57, v57, v33
    v_mul_f32 v58, v58, v34
    v_mul_f32 v59, v59, v35
    v_exp_f32 v56, v56
    v_exp_f32 v57, v57
    v_exp_f32 v58, v58
    v_exp_f32 v59, v59
    v_add_f32 v56, 1.0, v56
    v_add_f32 v57, 1.0, v57
    v_add_f32 v58, 1.0, v58
    v_add_f32 v59, 1.0, v59
    v_rcp_f32 v56, v56
    v_rcp_f32 v57, v57
    v_rcp_f32 v58, v58
    v_rcp_f32 v59, v59
    v_mul_f32 v32, v32, v56
    v_mul_f32 v33, v33, v57
    v_mul_f32 v34, v34, v58
    v_mul_f32 v35, v35, v59
    v_cvt_pk_bf16_f32 v48, v32, v33
    v_cvt_pk_bf16_f32 v49, v34, v35
    v_lshlrev_b32 v36, 16, v50
    v_and_b32 v37, s35, v50
    v_lshlrev_b32 v38, 16, v51
    v_and_b32 v39, s35, v51
    v_mul_f32 v60, v36, v36
    v_mul_f32 v61, v37, v37
    v_mul_f32 v62, v38, v38
    v_mul_f32 v63, v39, v39
    v_fma_f32 v60, v60, s32, v10
    v_fma_f32 v61, v61, s32, v10
    v_fma_f32 v62, v62, s32, v10
    v_fma_f32 v63, v63, s32, v10
    v_mul_f32 v60, v60, v36
    v_mul_f32 v61, v61, v37
    v_mul_f32 v62, v62, v38
    v_mul_f32 v63, v63, v39
    v_exp_f32 v60, v60
    v_exp_f32 v61, v61
    v_exp_f32 v62, v62
    v_exp_f32 v63, v63
    v_add_f32 v60, 1.0, v60
    v_add_f32 v61, 1.0, v61
    v_add_f32 v62, 1.0, v62
    v_add_f32 v63, 1.0, v63
    v_rcp_f32 v60, v60
    v_rcp_f32 v61, v61
    v_rcp_f32 v62, v62
    v_rcp_f32 v63, v63
    v_mul_f32 v36, v36, v60
    v_mul_f32 v37, v37, v61
    v_mul_f32 v38, v38, v62
    v_mul_f32 v39, v39, v63
    v_cvt_pk_bf16_f32 v50, v36, v37
    v_cvt_pk_bf16_f32 v51, v38, v39
    v_lshlrev_b32 v40, 16, v52
    v_and_b32 v41, s35, v52
    v_lshlrev_b32 v42, 16, v53
    v_and_b32 v43, s35, v53
    v_mul_f32 v56, v40, v40
    v_mul_f32 v57, v41, v41
    v_mul_f32 v58, v42, v42
    v_mul_f32 v59, v43, v43
    v_fma_f32 v56, v56, s32, v10
    v_fma_f32 v57, v57, s32, v10
    v_fma_f32 v58, v58, s32, v10
    v_fma_f32 v59, v59, s32, v10
    v_mul_f32 v56, v56, v40
    v_mul_f32 v57, v57, v41
    v_mul_f32 v58, v58, v42
    v_mul_f32 v59, v59, v43
    v_exp_f32 v56, v56
    v_exp_f32 v57, v57
    v_exp_f32 v58, v58
    v_exp_f32 v59, v59
    v_add_f32 v56, 1.0, v56
    v_add_f32 v57, 1.0, v57
    v_add_f32 v58, 1.0, v58
    v_add_f32 v59, 1.0, v59
    v_rcp_f32 v56, v56
    v_rcp_f32 v57, v57
    v_rcp_f32 v58, v58
    v_rcp_f32 v59, v59
    v_mul_f32 v40, v40, v56
    v_mul_f32 v41, v41, v57
    v_mul_f32 v42, v42, v58
    v_mul_f32 v43, v43, v59
    v_cvt_pk_bf16_f32 v52, v40, v41
    v_cvt_pk_bf16_f32 v53, v42, v43
    v_lshlrev_b32 v44, 16, v54
    v_and_b32 v45, s35, v54
    v_lshlrev_b32 v46, 16, v55
    v_and_b32 v47, s35, v55
    v_mul_f32 v60, v44, v44
    v_mul_f32 v61, v45, v45
    v_mul_f32 v62, v46, v46
    v_mul_f32 v63, v47, v47
    v_fma_f32 v60, v60, s32, v10
    v_fma_f32 v61, v61, s32, v10
    v_fma_f32 v62, v62, s32, v10
    v_fma_f32 v63, v63, s32, v10
    v_mul_f32 v60, v60, v44
    v_mul_f32 v61, v61, v45
    v_mul_f32 v62, v62, v46
    v_mul_f32 v63, v63, v47
    v_exp_f32 v60, v60
    v_exp_f32 v61, v61
    v_exp_f32 v62, v62
    v_exp_f32 v63, v63
    v_add_f32 v60, 1.0, v60
    v_add_f32 v61, 1.0, v61
    v_add_f32 v62, 1.0, v62
    v_add_f32 v63, 1.0, v63
    v_rcp_f32 v60, v60
    v_rcp_f32 v61, v61
    v_rcp_f32 v62, v62
    v_rcp_f32 v63, v63
    v_mul_f32 v44, v44, v60
    v_mul_f32 v45, v45, v61
    v_mul_f32 v46, v46, v62
    v_mul_f32 v47, v47, v63
    v_cvt_pk_bf16_f32 v54, v44, v45
    v_cvt_pk_bf16_f32 v55, v46, v47
    s_lshl_b32 s16, s28, 1
    s_add_u32 s16, s16, s63
    s_lshl_b32 s16, s16, 11
    s_mul_i32 s26, s25, 147456
    s_add_u32 s26, s26, s16
    s_add_u32 s26, s26, 6291456
    buffer_store_dwordx4 v[48:51], v2, s[8:11], s26 offen sc0 sc1
    buffer_store_dwordx4 v[52:55], v2, s[8:11], s26 offen offset:1024 sc0 sc1
EP5_X:
    s_branch H_FIN
H_LASTE:
    s_setprio 2
    s_lshl_b32 s15, s12, 2
    s_add_u32 s15, s15, 157840
    v_mov_b32 v3, s15
    s_mov_b32 s92, 0
XW2:
    ds_read_b32 v4, v3
    s_waitcnt lgkmcnt(0)
    v_readfirstlane_b32 s15, v4
    s_add_u32 s92, s92, 1
    s_cmp_gt_u32 s92, 0x80000
    s_cbranch_scc1 XW2_X
    s_cmp_eq_u32 s15, 0
    s_cbranch_scc1 XW2
XW2_X:
    ds_read_b128 v[48:51], v14 offset:0
    ds_read_b128 v[52:55], v14 offset:1024
    s_lshr_b32 s85, s22, 1
    s_lshl_b32 s17, s85, 3
    s_lshr_b32 s37, s18, s17
    s_cmp_ge_u32 s85, 4
    s_cselect_b32 s37, 3, s37
    s_and_b32 s62, s37, 3
    s_bfe_u32 s28, s37, 0x60002
    s_and_b32 s63, s22, 1
    s_and_b32 s17, s13, 1
    s_cmp_eq_u32 s22, 6
    s_cselect_b32 s63, s17, s63
    s_waitcnt lgkmcnt(0)
    s_cmp_eq_u32 s62, 2
    s_cbranch_scc1 EP6_M
    s_cmp_eq_u32 s62, 1
    s_cbranch_scc1 EP6_V
    s_cmp_ge_u32 s28, 7
    s_cselect_b32 s16, 7, 0
    s_mov_b32 s26, 0
    s_cselect_b32 s26, 2097152, s26
    s_mov_b32 s15, 0
    s_cselect_b32 s15, 0x3f803f80, s15
    v_mov_b32 v11, s15
    s_sub_u32 s16, s28, s16
    s_lshl_b32 s15, s25, 11
    s_add_u32 s26, s26, s15
    s_cmp_eq_u32 s62, 3
    s_cselect_b32 s26, 0x40000000, s26
    s_lshl_b32 s16, s16, 3
    s_lshl_b32 s15, s63, 2
    s_add_u32 s16, s16, s15
    v_add_u32 v5, s16, v8
    v_permlane32_swap_b32 v48, v50
    v_permlane32_swap_b32 v49, v51
    v_permlane32_swap_b32 v52, v54
    v_permlane32_swap_b32 v53, v55
    v_add_u32 v60, 0, v5
    v_mul_u32_u24 v3, 37, v60
    v_lshrrev_b32 v3, 8, v3
    v_mul_u32_u24 v4, 7, v3
    v_sub_u32 v4, v60, v4
    v_lshl_add_u32 v58, v3, 18, v9
    v_cmp_lt_u32 vcc, 3, v4
    v_mov_b32 v64, v11
    s_nop 0
    v_cndmask_b32 v60, 0, v12, vcc
    v_lshl_add_u32 v56, v4, 9, v58
    v_add_u32 v56, v56, v60
    v_cmp_eq_u32 vcc, 3, v4
    v_mov_b32 v65, v11
    v_mov_b32 v66, v50
    v_mov_b32 v67, v51
    v_cndmask_b32 v50, v50, v11, vcc
    v_cndmask_b32 v51, v51, v11, vcc
    v_add_u32 v58, 0x20000, v58
    v_cndmask_b32 v58, v13, v58, vcc
    v_add_u32 v60, 2, v5
    v_mul_u32_u24 v3, 37, v60
    v_lshrrev_b32 v3, 8, v3
    v_mul_u32_u24 v4, 7, v3
    v_sub_u32 v4, v60, v4
    v_lshl_add_u32 v59, v3, 18, v9
    v_cmp_lt_u32 vcc, 3, v4
    v_mov_b32 v68, v11
    s_nop 0
    v_cndmask_b32 v60, 0, v12, vcc
    v_lshl_add_u32 v57, v4, 9, v59
    v_add_u32 v57, v57, v60
    v_cmp_eq_u32 vcc, 3, v4
    v_mov_b32 v69, v11
    v_mov_b32 v70, v54
    v_mov_b32 v71, v55
    v_cndmask_b32 v54, v54, v11, vcc
    v_cndmask_b32 v55, v55, v11, vcc
    v_add_u32 v59, 0x20000, v59
    v_cndmask_b32 v59, v13, v59, vcc
    buffer_store_dwordx4 v[48:51], v56, s[8:11], s26 offen sc0 sc1
    buffer_store_dwordx4 v[64:67], v58, s[8:11], s26 offen sc0 sc1
    buffer_store_dwordx4 v[52:55], v57, s[8:11], s26 offen sc0 sc1
    buffer_store_dwordx4 v[68:71], v59, s[8:11], s26 offen sc0 sc1
    s_branch EP6_X
EP6_V:
    s_sub_u32 s16, s28, 14
    s_lshl_b32 s16, s16, 6
    s_lshl_b32 s15, s63, 5
    s_add_u32 s16, s16, s15
    s_lshl_b32 s15, s25, 11
    s_add_u32 s26, s15, 4194304
    v_lshrrev_b32 v3, 4, v9
    v_add_u32 v3, s16, v3
    v_mul_u32_u24 v4, 2341, v3
    v_lshrrev_b32 v4, 16, v4
    v_mul_u32_u24 v5, 28, v4
    v_sub_u32 v3, v3, v5
    v_lshlrev_b32 v3, 4, v3
    v_lshlrev_b32 v4, 17, v4
    v_add_u32 v3, v3, v4
    v_lshlrev_b32 v4, 9, v8
    v_add_u32 v56, v3, v4
    buffer_store_dwordx4 v[48:51], v56, s[8:11], s26 offen sc0 sc1
    buffer_store_dwordx4 v[52:55], v56, s[8:11], s26 offen offset:1024 sc0 sc1
    s_branch EP6_X
EP6_M:
    v_lshlrev_b32 v32, 16, v48
    v_and_b32 v33, s35, v48
    v_lshlrev_b32 v34, 16, v49
    v_and_b32 v35, s35, v49
    v_mul_f32 v56, v32, v32
    v_mul_f32 v57, v33, v33
    v_mul_f32 v58, v34, v34
    v_mul_f32 v59, v35, v35
    v_fma_f32 v56, v56, s32, v10
    v_fma_f32 v57, v57, s32, v10
    v_fma_f32 v58, v58, s32, v10
    v_fma_f32 v59, v59, s32, v10
    v_mul_f32 v56, v56, v32
    v_mul_f32 v57, v57, v33
    v_mul_f32 v58, v58, v34
    v_mul_f32 v59, v59, v35
    v_exp_f32 v56, v56
    v_exp_f32 v57, v57
    v_exp_f32 v58, v58
    v_exp_f32 v59, v59
    v_add_f32 v56, 1.0, v56
    v_add_f32 v57, 1.0, v57
    v_add_f32 v58, 1.0, v58
    v_add_f32 v59, 1.0, v59
    v_rcp_f32 v56, v56
    v_rcp_f32 v57, v57
    v_rcp_f32 v58, v58
    v_rcp_f32 v59, v59
    v_mul_f32 v32, v32, v56
    v_mul_f32 v33, v33, v57
    v_mul_f32 v34, v34, v58
    v_mul_f32 v35, v35, v59
    v_cvt_pk_bf16_f32 v48, v32, v33
    v_cvt_pk_bf16_f32 v49, v34, v35
    v_lshlrev_b32 v36, 16, v50
    v_and_b32 v37, s35, v50
    v_lshlrev_b32 v38, 16, v51
    v_and_b32 v39, s35, v51
    v_mul_f32 v60, v36, v36
    v_mul_f32 v61, v37, v37
    v_mul_f32 v62, v38, v38
    v_mul_f32 v63, v39, v39
    v_fma_f32 v60, v60, s32, v10
    v_fma_f32 v61, v61, s32, v10
    v_fma_f32 v62, v62, s32, v10
    v_fma_f32 v63, v63, s32, v10
    v_mul_f32 v60, v60, v36
    v_mul_f32 v61, v61, v37
    v_mul_f32 v62, v62, v38
    v_mul_f32 v63, v63, v39
    v_exp_f32 v60, v60
    v_exp_f32 v61, v61
    v_exp_f32 v62, v62
    v_exp_f32 v63, v63
    v_add_f32 v60, 1.0, v60
    v_add_f32 v61, 1.0, v61
    v_add_f32 v62, 1.0, v62
    v_add_f32 v63, 1.0, v63
    v_rcp_f32 v60, v60
    v_rcp_f32 v61, v61
    v_rcp_f32 v62, v62
    v_rcp_f32 v63, v63
    v_mul_f32 v36, v36, v60
    v_mul_f32 v37, v37, v61
    v_mul_f32 v38, v38, v62
    v_mul_f32 v39, v39, v63
    v_cvt_pk_bf16_f32 v50, v36, v37
    v_cvt_pk_bf16_f32 v51, v38, v39
    v_lshlrev_b32 v40, 16, v52
    v_and_b32 v41, s35, v52
    v_lshlrev_b32 v42, 16, v53
    v_and_b32 v43, s35, v53
    v_mul_f32 v56, v40, v40
    v_mul_f32 v57, v41, v41
    v_mul_f32 v58, v42, v42
    v_mul_f32 v59, v43, v43
    v_fma_f32 v56, v56, s32, v10
    v_fma_f32 v57, v57, s32, v10
    v_fma_f32 v58, v58, s32, v10
    v_fma_f32 v59, v59, s32, v10
    v_mul_f32 v56, v56, v40
    v_mul_f32 v57, v57, v41
    v_mul_f32 v58, v58, v42
    v_mul_f32 v59, v59, v43
    v_exp_f32 v56, v56
    v_exp_f32 v57, v57
    v_exp_f32 v58, v58
    v_exp_f32 v59, v59
    v_add_f32 v56, 1.0, v56
    v_add_f32 v57, 1.0, v57
    v_add_f32 v58, 1.0, v58
    v_add_f32 v59, 1.0, v59
    v_rcp_f32 v56, v56
    v_rcp_f32 v57, v57
    v_rcp_f32 v58, v58
    v_rcp_f32 v59, v59
    v_mul_f32 v40, v40, v56
    v_mul_f32 v41, v41, v57
    v_mul_f32 v42, v42, v58
    v_mul_f32 v43, v43, v59
    v_cvt_pk_bf16_f32 v52, v40, v41
    v_cvt_pk_bf16_f32 v53, v42, v43
    v_lshlrev_b32 v44, 16, v54
    v_and_b32 v45, s35, v54
    v_lshlrev_b32 v46, 16, v55
    v_and_b32 v47, s35, v55
    v_mul_f32 v60, v44, v44
    v_mul_f32 v61, v45, v45
    v_mul_f32 v62, v46, v46
    v_mul_f32 v63, v47, v47
    v_fma_f32 v60, v60, s32, v10
    v_fma_f32 v61, v61, s32, v10
    v_fma_f32 v62, v62, s32, v10
    v_fma_f32 v63, v63, s32, v10
    v_mul_f32 v60, v60, v44
    v_mul_f32 v61, v61, v45
    v_mul_f32 v62, v62, v46
    v_mul_f32 v63, v63, v47
    v_exp_f32 v60, v60
    v_exp_f32 v61, v61
    v_exp_f32 v62, v62
    v_exp_f32 v63, v63
    v_add_f32 v60, 1.0, v60
    v_add_f32 v61, 1.0, v61
    v_add_f32 v62, 1.0, v62
    v_add_f32 v63, 1.0, v63
    v_rcp_f32 v60, v60
    v_rcp_f32 v61, v61
    v_rcp_f32 v62, v62
    v_rcp_f32 v63, v63
    v_mul_f32 v44, v44, v60
    v_mul_f32 v45, v45, v61
    v_mul_f32 v46, v46, v62
    v_mul_f32 v47, v47, v63
    v_cvt_pk_bf16_f32 v54, v44, v45
    v_cvt_pk_bf16_f32 v55, v46, v47
    s_lshl_b32 s16, s28, 1
    s_add_u32 s16, s16, s63
    s_lshl_b32 s16, s16, 11
    s_mul_i32 s26, s25, 147456
    s_add_u32 s26, s26, s16
    s_add_u32 s26, s26, 6291456
    buffer_store_dwordx4 v[48:51], v2, s[8:11], s26 offen sc0 sc1
    buffer_store_dwordx4 v[52:55], v2, s[8:11], s26 offen offset:1024 sc0 sc1
EP6_X:
H_FIN:
    s_mov_b32 s98, s13
    s_mov_b32 s99, s14
    s_cmp_ge_u32 s2, 224
    s_cbranch_scc1 MG_IDLE
    s_setprio 2
    s_load_dwordx2 s[24:25], s[0:1], 48
    s_load_dwordx2 s[26:27], s[0:1], 16
    s_load_dwordx2 s[28:29], s[0:1], 0
    s_load_dwordx2 s[30:31], s[0:1], 56
    s_load_dwordx2 s[32:33], s[0:1], 64
    s_and_b32 s15, s2, 7
    s_lshr_b32 s16, s2, 3
    s_mul_i32 s13, s16, 37
    s_lshr_b32 s13, s13, 8
    s_mul_i32 s14, s13, 7
    s_sub_u32 s14, s16, s14
    s_lshl_b32 s15, s15, 2
    s_add_u32 s13, s13, s15
    s_and_b32 s22, s12, 1
    s_lshr_b32 s21, s12, 1
    v_mov_b32 v12, 0
    v_mov_b32 v13, 1
    v_mov_b32 v22, 157696
    s_mul_i32 s15, s22, 147456
    v_add_u32 v3, s15, v2
    s_xor_b32 s15, s22, 1
    s_mul_i32 s15, s15, 147456
    v_add_u32 v4, s15, v2
    v_lshrrev_b32 v6, 3, v1
    v_mul_u32_u24 v5, 896, v6
    v_bfe_u32 v6, v1, 4, 1
    v_lshlrev_b32 v6, 2, v6
    v_and_b32 v7, 7, v1
    v_xor_b32 v6, v6, v7
    v_lshlrev_b32 v6, 4, v6
    v_add_u32 v5, v5, v6
    s_lshl_b32 s15, s14, 7
    v_add_u32 v5, s15, v5
    v_lshrrev_b32 v6, 5, v1
    v_lshlrev_b32 v6, 2, v6
    v_bfe_u32 v7, v1, 2, 2
    v_add_u32 v6, v6, v7
    v_lshlrev_b32 v8, 7, v6
    v_lshrrev_b32 v7, 1, v7
    v_lshlrev_b32 v7, 6, v7
    v_add_u32 v8, v8, v7
    v_bfe_u32 v6, v1, 4, 1
    v_lshlrev_b32 v6, 5, v6
    v_add_u32 v8, v8, v6
    v_and_b32 v6, 3, v1
    v_lshlrev_b32 v6, 3, v6
    v_add_u32 v8, v8, v6
    s_lshl_b32 s15, s21, 6
    v_xor_b32 v8, s15, v8
    s_mul_i32 s19, s12, 24576
    s_add_u32 s19, s19, 51200
    v_add_u32 v8, s19, v8
    v_xor_b32 v9, 64, v8
    s_mul_i32 s17, s13, 294912
    s_lshl_b32 s15, s12, 11
    s_add_u32 s17, s17, s15
    s_add_u32 s17, s17, 6291456
    s_mul_i32 s18, s12, 28672
    s_lshl_b32 s15, s21, 3
    s_mul_i32 s34, s15, 25088
    v_and_b32 v6, 31, v1
    v_mul_u32_u24 v10, 896, v6
    v_lshrrev_b32 v6, 5, v1
    v_lshlrev_b32 v11, 3, v6
    s_lshl_b32 s15, s14, 7
    s_lshl_b32 s16, s21, 6
    s_add_u32 s15, s15, s16
    v_add_u32 v11, s15, v11
    v_add_u32 v10, v10, v11
    s_lshl_b32 s15, s13, 1
    s_add_u32 s15, s15, s22
    s_mul_i32 s15, s15, 28672
    v_add_u32 v10, s15, v10
    v_and_b32 v6, 15, v1
    v_lshlrev_b32 v6, 4, v6
    s_lshr_b32 s15, s13, 1
    v_add_u32 v6, s15, v6
    v_lshlrev_b32 v28, 7, v6
    v_min_u32 v6, 10, v1
    v_add_u32 v6, 5, v6
    v_lshlrev_b32 v6, 4, v6
    v_add_u32 v6, s15, v6
    v_lshlrev_b32 v29, 7, v6
    s_mul_i32 s35, s13, 294912
    s_add_u32 s35, s35, 6291456
    s_waitcnt lgkmcnt(0)
    s_mov_b32 s36, s24
    s_and_b32 s37, s25, 0xffff
    s_mov_b32 s38, 1605632
    s_mov_b32 s39, 0x00020000
    s_mov_b32 s40, s26
    s_and_b32 s41, s27, 0xffff
    s_mov_b32 s42, 401408
    s_mov_b32 s43, 0x00020000
    s_mov_b32 s44, s28
    s_and_b32 s45, s29, 0xffff
    s_mov_b32 s46, 1835008
    s_mov_b32 s47, 0x00020000
    s_mov_b32 s48, s30
    s_and_b32 s49, s31, 0xffff
    s_mov_b32 s50, 896
    s_mov_b32 s51, 0x00020000
    s_mov_b32 s52, s32
    s_and_b32 s53, s33, 0xffff
    s_mov_b32 s54, 1835008
    s_mov_b32 s55, 0x00020000
    s_lshl_b32 s15, s12, 2
    v_add_u32 v6, s15, v22
    s_waitcnt vmcnt(4)
    s_waitcnt lgkmcnt(0)
    ds_write_b32 v6, v13 offset:96
    s_mov_b32 s62, 0
    s_branch LW3_1
LW3:
    s_sleep 1
LW3_1:
    s_add_u32 s62, s62, 1
    s_cmp_gt_u32 s62, 0x40000
    s_cbranch_scc1 LW3_X
    ds_read_b128 v[24:27], v22 offset:96
    s_waitcnt lgkmcnt(0)
    v_and_b32 v24, v24, v25
    v_and_b32 v26, v26, v27
    v_and_b32 v24, v24, v26
    s_nop 0
    v_readfirstlane_b32 s15, v24
    s_nop 0
    s_cmp_eq_u32 s15, 1
    s_cbranch_scc0 LW3
LW3_X:
    s_setprio 0
    s_mov_b32 s63, 19988480
    buffer_load_dword v24, v29, s[8:11], s63 offen sc0 sc1
    s_cmp_eq_u32 s21, 0
    s_mov_b32 s18, 14
    s_cselect_b32 s18, 10, s18
    s_add_u32 s18, s18, s22
    s_mul_i32 s18, s18, 28672
    s_add_u32 s15, s19, 0
    s_mov_b32 m0, s15
    s_nop 0
    buffer_load_dwordx4 v5, s[36:39], s18 offen lds
    s_add_u32 s15, s19, 1024
    s_mov_b32 m0, s15
    s_add_u32 s20, s18, 7168
    buffer_load_dwordx4 v5, s[36:39], s20 offen lds
    s_add_u32 s15, s19, 2048
    s_mov_b32 m0, s15
    s_add_u32 s20, s18, 14336
    buffer_load_dwordx4 v5, s[36:39], s20 offen lds
    s_add_u32 s15, s19, 3072
    s_mov_b32 m0, s15
    s_add_u32 s20, s18, 21504
    buffer_load_dwordx4 v5, s[36:39], s20 offen lds
    s_waitcnt vmcnt(5)
    v_mov_b32 v30, 157828
    v_mov_b32 v31, 1
    s_mov_b64 exec, 1
    ds_add_rtn_u32 v23, v30, v31
    s_waitcnt lgkmcnt(0)
    v_readfirstlane_b32 s95, v23
    s_nop 3
    s_cmp_lg_u32 s95, 3
    s_cbranch_scc1 PUB_M
    s_lshl_b32 s95, s98, 4
    s_add_u32 s95, s95, s99
    s_lshl_b32 s95, s95, 7
    s_add_u32 s95, s95, 19955712
    v_mov_b32 v31, s94
    v_mov_b32 v30, 0
    buffer_store_dword v31, v30, s[8:11], s95 offen sc0 sc1
PUB_M:
    s_mov_b64 exec, -1
    s_waitcnt vmcnt(4)
    v_cmp_ne_u32 vcc, s94, v24
    s_nop 4
    s_cbranch_vccz GE_OK
    s_mov_b32 s61, 0
    s_mov_b32 s63, 19988480
    s_branch GP_GE_1
GP_GE:
    s_sleep 2
GP_GE_1:
    buffer_load_dword v7, v29, s[8:11], s63 offen sc0 sc1
    s_waitcnt vmcnt(0)
    v_cmp_ne_u32 vcc, s94, v7
    s_add_u32 s61, s61, 1
    s_cmp_gt_u32 s61, 0x20000
    s_cbranch_scc1 GP_GE_X
    s_cbranch_vccnz GP_GE
GP_GE_X:
GE_OK:
    s_cmp_eq_u32 s21, 0
    s_mov_b32 s17, 14
    s_cselect_b32 s17, 10, s17
    s_add_u32 s17, s17, s22
    s_lshl_b32 s17, s17, 11
    s_add_u32 s17, s17, s35
    buffer_load_dwordx4 v[96:99], v3, s[8:11], s17 offen sc0 sc1
    buffer_load_dwordx4 v[100:103], v3, s[8:11], s17 offen offset:1024 sc0 sc1
    buffer_load_dwordx4 v[104:107], v4, s[8:11], s17 offen sc0 sc1
    buffer_load_dwordx4 v[108:111], v4, s[8:11], s17 offen offset:1024 sc0 sc1
    s_cmp_eq_u32 s21, 0
    s_mov_b32 s18, 22
    s_cselect_b32 s18, 18, s18
    s_add_u32 s18, s18, s22
    s_mul_i32 s18, s18, 28672
    s_add_u32 s15, s19, 4096
    s_mov_b32 m0, s15
    s_nop 0
    buffer_load_dwordx4 v5, s[36:39], s18 offen lds
    s_add_u32 s15, s19, 5120
    s_mov_b32 m0, s15
    s_add_u32 s20, s18, 7168
    buffer_load_dwordx4 v5, s[36:39], s20 offen lds
    s_add_u32 s15, s19, 6144
    s_mov_b32 m0, s15
    s_add_u32 s20, s18, 14336
    buffer_load_dwordx4 v5, s[36:39], s20 offen lds
    s_add_u32 s15, s19, 7168
    s_mov_b32 m0, s15
    s_add_u32 s20, s18, 21504
    buffer_load_dwordx4 v5, s[36:39], s20 offen lds
    s_cmp_eq_u32 s21, 0
    s_mov_b32 s17, 22
    s_cselect_b32 s17, 18, s17
    s_add_u32 s17, s17, s22
    s_lshl_b32 s17, s17, 11
    s_add_u32 s17, s17, s35
    buffer_load_dwordx4 v[112:115], v3, s[8:11], s17 offen sc0 sc1
    buffer_load_dwordx4 v[116:119], v3, s[8:11], s17 offen offset:1024 sc0 sc1
    buffer_load_dwordx4 v[120:123], v4, s[8:11], s17 offen sc0 sc1
    buffer_load_dwordx4 v[124:127], v4, s[8:11], s17 offen offset:1024 sc0 sc1
    s_cmp_eq_u32 s21, 0
    s_mov_b32 s18, 30
    s_cselect_b32 s18, 26, s18
    s_add_u32 s18, s18, s22
    s_mul_i32 s18, s18, 28672
    s_add_u32 s15, s19, 8192
    s_mov_b32 m0, s15
    s_nop 0
    buffer_load_dwordx4 v5, s[36:39], s18 offen lds
    s_add_u32 s15, s19, 9216
    s_mov_b32 m0, s15
    s_add_u32 s20, s18, 7168
    buffer_load_dwordx4 v5, s[36:39], s20 offen lds
    s_add_u32 s15, s19, 10240
    s_mov_b32 m0, s15
    s_add_u32 s20, s18, 14336
    buffer_load_dwordx4 v5, s[36:39], s20 offen lds
    s_add_u32 s15, s19, 11264
    s_mov_b32 m0, s15
    s_add_u32 s20, s18, 21504
    buffer_load_dwordx4 v5, s[36:39], s20 offen lds
    s_cmp_eq_u32 s21, 0
    s_mov_b32 s17, 30
    s_cselect_b32 s17, 26, s17
    s_add_u32 s17, s17, s22
    s_lshl_b32 s17, s17, 11
    s_add_u32 s17, s17, s35
    buffer_load_dwordx4 v[128:131], v3, s[8:11], s17 offen sc0 sc1
    buffer_load_dwordx4 v[132:135], v3, s[8:11], s17 offen offset:1024 sc0 sc1
    buffer_load_dwordx4 v[136:139], v4, s[8:11], s17 offen sc0 sc1
    buffer_load_dwordx4 v[140:143], v4, s[8:11], s17 offen offset:1024 sc0 sc1
    s_cmp_eq_u32 s21, 0
    s_mov_b32 s18, 38
    s_cselect_b32 s18, 34, s18
    s_add_u32 s18, s18, s22
    s_mul_i32 s18, s18, 28672
    s_add_u32 s15, s19, 12288
    s_mov_b32 m0, s15
    s_nop 0
    buffer_load_dwordx4 v5, s[36:39], s18 offen lds
    s_add_u32 s15, s19, 13312
    s_mov_b32 m0, s15
    s_add_u32 s20, s18, 7168
    buffer_load_dwordx4 v5, s[36:39], s20 offen lds
    s_add_u32 s15, s19, 14336
    s_mov_b32 m0, s15
    s_add_u32 s20, s18, 14336
    buffer_load_dwordx4 v5, s[36:39], s20 offen lds
    s_add_u32 s15, s19, 15360
    s_mov_b32 m0, s15
    s_add_u32 s20, s18, 21504
    buffer_load_dwordx4 v5, s[36:39], s20 offen lds
    s_cmp_eq_u32 s21, 0
    s_mov_b32 s17, 38
    s_cselect_b32 s17, 34, s17
    s_add_u32 s17, s17, s22
    s_lshl_b32 s17, s17, 11
    s_add_u32 s17, s17, s35
    buffer_load_dwordx4 v[144:147], v3, s[8:11], s17 offen sc0 sc1
    buffer_load_dwordx4 v[148:151], v3, s[8:11], s17 offen offset:1024 sc0 sc1
    buffer_load_dwordx4 v[152:155], v4, s[8:11], s17 offen sc0 sc1
    buffer_load_dwordx4 v[156:159], v4, s[8:11], s17 offen offset:1024 sc0 sc1
    s_waitcnt vmcnt(24)
    ds_read_b64_tr_b16 v[176:177], v8 offset:0
    ds_read_b64_tr_b16 v[178:179], v8 offset:1024
    ds_read_b64_tr_b16 v[180:181], v9 offset:0
    ds_read_b64_tr_b16 v[182:183], v9 offset:1024
    ds_read_b64_tr_b16 v[184:185], v8 offset:2048
    ds_read_b64_tr_b16 v[186:187], v8 offset:3072
    ds_read_b64_tr_b16 v[188:189], v9 offset:2048
    ds_read_b64_tr_b16 v[190:191], v9 offset:3072
    s_waitcnt lgkmcnt(4)
    v_mfma_f32_32x32x16_bf16 v[32:47], v[176:179], v[96:99], 0
    v_mfma_f32_32x32x16_bf16 v[48:63], v[176:179], v[104:107], 0
    v_mfma_f32_32x32x16_bf16 v[64:79], v[180:183], v[96:99], 0
    v_mfma_f32_32x32x16_bf16 v[80:95], v[180:183], v[104:107], 0
    s_waitcnt lgkmcnt(0)
    v_mfma_f32_32x32x16_bf16 v[32:47], v[184:187], v[100:103], v[32:47]
    v_mfma_f32_32x32x16_bf16 v[48:63], v[184:187], v[108:111], v[48:63]
    v_mfma_f32_32x32x16_bf16 v[64:79], v[188:191], v[100:103], v[64:79]
    v_mfma_f32_32x32x16_bf16 v[80:95], v[188:191], v[108:111], v[80:95]
    s_cmp_eq_u32 s21, 0
    s_mov_b32 s18, 46
    s_cselect_b32 s18, 42, s18
    s_add_u32 s18, s18, s22
    s_mul_i32 s18, s18, 28672
    s_add_u32 s15, s19, 16384
    s_mov_b32 m0, s15
    s_nop 0
    buffer_load_dwordx4 v5, s[36:39], s18 offen lds
    s_add_u32 s15, s19, 17408
    s_mov_b32 m0, s15
    s_add_u32 s20, s18, 7168
    buffer_load_dwordx4 v5, s[36:39], s20 offen lds
    s_add_u32 s15, s19, 18432
    s_mov_b32 m0, s15
    s_add_u32 s20, s18, 14336
    buffer_load_dwordx4 v5, s[36:39], s20 offen lds
    s_add_u32 s15, s19, 19456
    s_mov_b32 m0, s15
    s_add_u32 s20, s18, 21504
    buffer_load_dwordx4 v5, s[36:39], s20 offen lds
    s_cmp_eq_u32 s21, 0
    s_mov_b32 s17, 46
    s_cselect_b32 s17, 42, s17
    s_add_u32 s17, s17, s22
    s_lshl_b32 s17, s17, 11
    s_add_u32 s17, s17, s35
    buffer_load_dwordx4 v[160:163], v3, s[8:11], s17 offen sc0 sc1
    buffer_load_dwordx4 v[164:167], v3, s[8:11], s17 offen offset:1024 sc0 sc1
    buffer_load_dwordx4 v[168:171], v4, s[8:11], s17 offen sc0 sc1
    buffer_load_dwordx4 v[172:175], v4, s[8:11], s17 offen offset:1024 sc0 sc1
    s_waitcnt vmcnt(24)
    ds_read_b64_tr_b16 v[192:193], v8 offset:4096
    ds_read_b64_tr_b16 v[194:195], v8 offset:5120
    ds_read_b64_tr_b16 v[196:197], v9 offset:4096
    ds_read_b64_tr_b16 v[198:199], v9 offset:5120
    ds_read_b64_tr_b16 v[200:201], v8 offset:6144
    ds_read_b64_tr_b16 v[202:203], v8 offset:7168
    ds_read_b64_tr_b16 v[204:205], v9 offset:6144
    ds_read_b64_tr_b16 v[206:207], v9 offset:7168
    s_waitcnt lgkmcnt(4)
    v_mfma_f32_32x32x16_bf16 v[32:47], v[192:195], v[112:115], v[32:47]
    v_mfma_f32_32x32x16_bf16 v[48:63], v[192:195], v[120:123], v[48:63]
    v_mfma_f32_32x32x16_bf16 v[64:79], v[196:199], v[112:115], v[64:79]
    v_mfma_f32_32x32x16_bf16 v[80:95], v[196:199], v[120:123], v[80:95]
    s_waitcnt lgkmcnt(0)
    v_mfma_f32_32x32x16_bf16 v[32:47], v[200:203], v[116:119], v[32:47]
    v_mfma_f32_32x32x16_bf16 v[48:63], v[200:203], v[124:127], v[48:63]
    v_mfma_f32_32x32x16_bf16 v[64:79], v[204:207], v[116:119], v[64:79]
    v_mfma_f32_32x32x16_bf16 v[80:95], v[204:207], v[124:127], v[80:95]
    s_add_u32 s15, s19, 20480
    s_mov_b32 m0, s15
    s_nop 0
    buffer_load_dwordx4 v5, s[40:43], s34 offen lds
    s_add_u32 s15, s19, 21504
    s_mov_b32 m0, s15
    s_add_u32 s20, s34, 7168
    buffer_load_dwordx4 v5, s[40:43], s20 offen lds
    s_add_u32 s15, s19, 22528
    s_mov_b32 m0, s15
    s_add_u32 s20, s34, 14336
    buffer_load_dwordx4 v5, s[40:43], s20 offen lds
    s_add_u32 s15, s19, 23552
    s_mov_b32 m0, s15
    s_add_u32 s20, s34, 21504
    buffer_load_dwordx4 v5, s[40:43], s20 offen lds
    s_add_u32 s34, s34, 25088
    buffer_load_dwordx2 v[14:15], v10, s[44:47], 0 offen offset:0
    buffer_load_dwordx2 v[16:17], v10, s[44:47], 0 offen offset:16
    buffer_load_dwordx2 v[18:19], v10, s[44:47], 0 offen offset:32
    buffer_load_dwordx2 v[20:21], v10, s[44:47], 0 offen offset:48
    s_cmp_eq_u32 s21, 0
    s_mov_b32 s18, 0
    s_cselect_b32 s18, 50, s18
    s_add_u32 s18, s18, s22
    s_mul_i32 s18, s18, 28672
    s_add_u32 s15, s19, 0
    s_mov_b32 m0, s15
    s_nop 0
    buffer_load_dwordx4 v5, s[36:39], s18 offen lds
    s_add_u32 s15, s19, 1024
    s_mov_b32 m0, s15
    s_add_u32 s20, s18, 7168
    buffer_load_dwordx4 v5, s[36:39], s20 offen lds
    s_add_u32 s15, s19, 2048
    s_mov_b32 m0, s15
    s_add_u32 s20, s18, 14336
    buffer_load_dwordx4 v5, s[36:39], s20 offen lds
    s_add_u32 s15, s19, 3072
    s_mov_b32 m0, s15
    s_add_u32 s20, s18, 21504
    buffer_load_dwordx4 v5, s[36:39], s20 offen lds
    s_mov_b32 s61, 0
    s_mov_b32 s63, 19955712
    s_branch GP_GH_1
GP_GH:
    s_sleep 2
GP_GH_1:
    buffer_load_dword v7, v28, s[8:11], s63 offen sc0 sc1
    s_waitcnt vmcnt(0)
    v_cmp_ne_u32 vcc, s94, v7
    s_add_u32 s61, s61, 1
    s_cmp_gt_u32 s61, 0x20000
    s_cbranch_scc1 GP_GH_X
    s_cbranch_vccnz GP_GH
GP_GH_X:
    s_cmp_eq_u32 s21, 0
    s_mov_b32 s17, 0
    s_cselect_b32 s17, 50, s17
    s_add_u32 s17, s17, s22
    s_lshl_b32 s17, s17, 11
    s_add_u32 s17, s17, s35
    buffer_load_dwordx4 v[96:99], v3, s[8:11], s17 offen sc0 sc1
    buffer_load_dwordx4 v[100:103], v3, s[8:11], s17 offen offset:1024 sc0 sc1
    buffer_load_dwordx4 v[104:107], v4, s[8:11], s17 offen sc0 sc1
    buffer_load_dwordx4 v[108:111], v4, s[8:11], s17 offen offset:1024 sc0 sc1
    ds_read_b64_tr_b16 v[176:177], v8 offset:8192
    ds_read_b64_tr_b16 v[178:179], v8 offset:9216
    ds_read_b64_tr_b16 v[180:181], v9 offset:8192
    ds_read_b64_tr_b16 v[182:183], v9 offset:9216
    ds_read_b64_tr_b16 v[184:185], v8 offset:10240
    ds_read_b64_tr_b16 v[186:187], v8 offset:11264
    ds_read_b64_tr_b16 v[188:189], v9 offset:10240
    ds_read_b64_tr_b16 v[190:191], v9 offset:11264
    s_waitcnt lgkmcnt(4)
    v_mfma_f32_32x32x16_bf16 v[32:47], v[176:179], v[128:131], v[32:47]
    v_mfma_f32_32x32x16_bf16 v[48:63], v[176:179], v[136:139], v[48:63]
    v_mfma_f32_32x32x16_bf16 v[64:79], v[180:183], v[128:131], v[64:79]
    v_mfma_f32_32x32x16_bf16 v[80:95], v[180:183], v[136:139], v[80:95]
    s_waitcnt lgkmcnt(0)
    v_mfma_f32_32x32x16_bf16 v[32:47], v[184:187], v[132:135], v[32:47]
    v_mfma_f32_32x32x16_bf16 v[48:63], v[184:187], v[140:143], v[48:63]
    v_mfma_f32_32x32x16_bf16 v[64:79], v[188:191], v[132:135], v[64:79]
    v_mfma_f32_32x32x16_bf16 v[80:95], v[188:191], v[140:143], v[80:95]
    s_cmp_eq_u32 s21, 0
    s_mov_b32 s18, 4
    s_cselect_b32 s18, 2, s18
    s_add_u32 s18, s18, s22
    s_mul_i32 s18, s18, 28672
    s_add_u32 s15, s19, 4096
    s_mov_b32 m0, s15
    s_nop 0
    buffer_load_dwordx4 v5, s[36:39], s18 offen lds
    s_add_u32 s15, s19, 5120
    s_mov_b32 m0, s15
    s_add_u32 s20, s18, 7168
    buffer_load_dwordx4 v5, s[36:39], s20 offen lds
    s_add_u32 s15, s19, 6144
    s_mov_b32 m0, s15
    s_add_u32 s20, s18, 14336
    buffer_load_dwordx4 v5, s[36:39], s20 offen lds
    s_add_u32 s15, s19, 7168
    s_mov_b32 m0, s15
    s_add_u32 s20, s18, 21504
    buffer_load_dwordx4 v5, s[36:39], s20 offen lds
    s_cmp_eq_u32 s21, 0
    s_mov_b32 s17, 4
    s_cselect_b32 s17, 2, s17
    s_add_u32 s17, s17, s22
    s_lshl_b32 s17, s17, 11
    s_add_u32 s17, s17, s35
    buffer_load_dwordx4 v[112:115], v3, s[8:11], s17 offen sc0 sc1
    buffer_load_dwordx4 v[116:119], v3, s[8:11], s17 offen offset:1024 sc0 sc1
    buffer_load_dwordx4 v[120:123], v4, s[8:11], s17 offen sc0 sc1
    buffer_load_dwordx4 v[124:127], v4, s[8:11], s17 offen offset:1024 sc0 sc1
    ds_read_b64_tr_b16 v[192:193], v8 offset:12288
    ds_read_b64_tr_b16 v[194:195], v8 offset:13312
    ds_read_b64_tr_b16 v[196:197], v9 offset:12288
    ds_read_b64_tr_b16 v[198:199], v9 offset:13312
    ds_read_b64_tr_b16 v[200:201], v8 offset:14336
    ds_read_b64_tr_b16 v[202:203], v8 offset:15360
    ds_read_b64_tr_b16 v[204:205], v9 offset:14336
    ds_read_b64_tr_b16 v[206:207], v9 offset:15360
    s_waitcnt lgkmcnt(4)
    v_mfma_f32_32x32x16_bf16 v[32:47], v[192:195], v[144:147], v[32:47]
    v_mfma_f32_32x32x16_bf16 v[48:63], v[192:195], v[152:155], v[48:63]
    v_mfma_f32_32x32x16_bf16 v[64:79], v[196:199], v[144:147], v[64:79]
    v_mfma_f32_32x32x16_bf16 v[80:95], v[196:199], v[152:155], v[80:95]
    s_waitcnt lgkmcnt(0)
    v_mfma_f32_32x32x16_bf16 v[32:47], v[200:203], v[148:151], v[32:47]
    v_mfma_f32_32x32x16_bf16 v[48:63], v[200:203], v[156:159], v[48:63]
    v_mfma_f32_32x32x16_bf16 v[64:79], v[204:207], v[148:151], v[64:79]
    v_mfma_f32_32x32x16_bf16 v[80:95], v[204:207], v[156:159], v[80:95]
    s_cmp_eq_u32 s21, 0
    s_mov_b32 s18, 8
    s_cselect_b32 s18, 6, s18
    s_add_u32 s18, s18, s22
    s_mul_i32 s18, s18, 28672
    s_add_u32 s15, s19, 8192
    s_mov_b32 m0, s15
    s_nop 0
    buffer_load_dwordx4 v5, s[36:39], s18 offen lds
    s_add_u32 s15, s19, 9216
    s_mov_b32 m0, s15
    s_add_u32 s20, s18, 7168
    buffer_load_dwordx4 v5, s[36:39], s20 offen lds
    s_add_u32 s15, s19, 10240
    s_mov_b32 m0, s15
    s_add_u32 s20, s18, 14336
    buffer_load_dwordx4 v5, s[36:39], s20 offen lds
    s_add_u32 s15, s19, 11264
    s_mov_b32 m0, s15
    s_add_u32 s20, s18, 21504
    buffer_load_dwordx4 v5, s[36:39], s20 offen lds
    s_cmp_eq_u32 s21, 0
    s_mov_b32 s17, 8
    s_cselect_b32 s17, 6, s17
    s_add_u32 s17, s17, s22
    s_lshl_b32 s17, s17, 11
    s_add_u32 s17, s17, s35
    buffer_load_dwordx4 v[128:131], v3, s[8:11], s17 offen sc0 sc1
    buffer_load_dwordx4 v[132:135], v3, s[8:11], s17 offen offset:1024 sc0 sc1
    buffer_load_dwordx4 v[136:139], v4, s[8:11], s17 offen sc0 sc1
    buffer_load_dwordx4 v[140:143], v4, s[8:11], s17 offen offset:1024 sc0 sc1
    ds_read_b64_tr_b16 v[176:177], v8 offset:16384
    ds_read_b64_tr_b16 v[178:179], v8 offset:17408
    ds_read_b64_tr_b16 v[180:181], v9 offset:16384
    ds_read_b64_tr_b16 v[182:183], v9 offset:17408
    ds_read_b64_tr_b16 v[184:185], v8 offset:18432
    ds_read_b64_tr_b16 v[186:187], v8 offset:19456
    ds_read_b64_tr_b16 v[188:189], v9 offset:18432
    ds_read_b64_tr_b16 v[190:191], v9 offset:19456
    s_waitcnt lgkmcnt(4)
    v_mfma_f32_32x32x16_bf16 v[32:47], v[176:179], v[160:163], v[32:47]
    v_mfma_f32_32x32x16_bf16 v[48:63], v[176:179], v[168:171], v[48:63]
    v_mfma_f32_32x32x16_bf16 v[64:79], v[180:183], v[160:163], v[64:79]
    v_mfma_f32_32x32x16_bf16 v[80:95], v[180:183], v[168:171], v[80:95]
    s_waitcnt lgkmcnt(0)
    v_mfma_f32_32x32x16_bf16 v[32:47], v[184:187], v[164:167], v[32:47]
    v_mfma_f32_32x32x16_bf16 v[48:63], v[184:187], v[172:175], v[48:63]
    v_mfma_f32_32x32x16_bf16 v[64:79], v[188:191], v[164:167], v[64:79]
    v_mfma_f32_32x32x16_bf16 v[80:95], v[188:191], v[172:175], v[80:95]
    ds_read_b64_tr_b16 v[208:209], v8 offset:20480
    ds_read_b64_tr_b16 v[210:211], v8 offset:21504
    ds_read_b64_tr_b16 v[212:213], v9 offset:20480
    ds_read_b64_tr_b16 v[214:215], v9 offset:21504
    ds_read_b64_tr_b16 v[216:217], v8 offset:22528
    ds_read_b64_tr_b16 v[218:219], v8 offset:23552
    ds_read_b64_tr_b16 v[220:221], v9 offset:22528
    ds_read_b64_tr_b16 v[222:223], v9 offset:23552
    s_waitcnt lgkmcnt(0)
    s_add_u32 s15, s19, 20480
    s_mov_b32 m0, s15
    s_nop 0
    buffer_load_dwordx4 v5, s[40:43], s34 offen lds
    s_add_u32 s15, s19, 21504
    s_mov_b32 m0, s15
    s_add_u32 s20, s34, 7168
    buffer_load_dwordx4 v5, s[40:43], s20 offen lds
    s_add_u32 s15, s19, 22528
    s_mov_b32 m0, s15
    s_add_u32 s20, s34, 14336
    buffer_load_dwordx4 v5, s[40:43], s20 offen lds
    s_add_u32 s15, s19, 23552
    s_mov_b32 m0, s15
    s_add_u32 s20, s34, 21504
    buffer_load_dwordx4 v5, s[40:43], s20 offen lds
    s_add_u32 s34, s34, 25088
    s_cmp_eq_u32 s21, 0
    s_mov_b32 s18, 16
    s_cselect_b32 s18, 12, s18
    s_add_u32 s18, s18, s22
    s_mul_i32 s18, s18, 28672
    s_add_u32 s15, s19, 12288
    s_mov_b32 m0, s15
    s_nop 0
    buffer_load_dwordx4 v5, s[36:39], s18 offen lds
    s_add_u32 s15, s19, 13312
    s_mov_b32 m0, s15
    s_add_u32 s20, s18, 7168
    buffer_load_dwordx4 v5, s[36:39], s20 offen lds
    s_add_u32 s15, s19, 14336
    s_mov_b32 m0, s15
    s_add_u32 s20, s18, 14336
    buffer_load_dwordx4 v5, s[36:39], s20 offen lds
    s_add_u32 s15, s19, 15360
    s_mov_b32 m0, s15
    s_add_u32 s20, s18, 21504
    buffer_load_dwordx4 v5, s[36:39], s20 offen lds
    s_cmp_eq_u32 s21, 0
    s_mov_b32 s17, 16
    s_cselect_b32 s17, 12, s17
    s_add_u32 s17, s17, s22
    s_lshl_b32 s17, s17, 11
    s_add_u32 s17, s17, s35
    buffer_load_dwordx4 v[144:147], v3, s[8:11], s17 offen sc0 sc1
    buffer_load_dwordx4 v[148:151], v3, s[8:11], s17 offen offset:1024 sc0 sc1
    buffer_load_dwordx4 v[152:155], v4, s[8:11], s17 offen sc0 sc1
    buffer_load_dwordx4 v[156:159], v4, s[8:11], s17 offen offset:1024 sc0 sc1
    s_waitcnt vmcnt(28)
    ds_read_b64_tr_b16 v[192:193], v8 offset:0
    ds_read_b64_tr_b16 v[194:195], v8 offset:1024
    ds_read_b64_tr_b16 v[196:197], v9 offset:0
    ds_read_b64_tr_b16 v[198:199], v9 offset:1024
    ds_read_b64_tr_b16 v[200:201], v8 offset:2048
    ds_read_b64_tr_b16 v[202:203], v8 offset:3072
    ds_read_b64_tr_b16 v[204:205], v9 offset:2048
    ds_read_b64_tr_b16 v[206:207], v9 offset:3072
    s_waitcnt lgkmcnt(4)
    v_mfma_f32_32x32x16_bf16 v[32:47], v[192:195], v[96:99], v[32:47]
    v_mfma_f32_32x32x16_bf16 v[48:63], v[192:195], v[104:107], v[48:63]
    v_mfma_f32_32x32x16_bf16 v[64:79], v[196:199], v[96:99], v[64:79]
    v_mfma_f32_32x32x16_bf16 v[80:95], v[196:199], v[104:107], v[80:95]
    s_waitcnt lgkmcnt(0)
    v_mfma_f32_32x32x16_bf16 v[32:47], v[200:203], v[100:103], v[32:47]
    v_mfma_f32_32x32x16_bf16 v[48:63], v[200:203], v[108:111], v[48:63]
    v_mfma_f32_32x32x16_bf16 v[64:79], v[204:207], v[100:103], v[64:79]
    v_mfma_f32_32x32x16_bf16 v[80:95], v[204:207], v[108:111], v[80:95]
    s_cmp_eq_u32 s21, 0
    s_mov_b32 s18, 24
    s_cselect_b32 s18, 20, s18
    s_add_u32 s18, s18, s22
    s_mul_i32 s18, s18, 28672
    s_add_u32 s15, s19, 16384
    s_mov_b32 m0, s15
    s_nop 0
    buffer_load_dwordx4 v5, s[36:39], s18 offen lds
    s_add_u32 s15, s19, 17408
    s_mov_b32 m0, s15
    s_add_u32 s20, s18, 7168
    buffer_load_dwordx4 v5, s[36:39], s20 offen lds
    s_add_u32 s15, s19, 18432
    s_mov_b32 m0, s15
    s_add_u32 s20, s18, 14336
    buffer_load_dwordx4 v5, s[36:39], s20 offen lds
    s_add_u32 s15, s19, 19456
    s_mov_b32 m0, s15
    s_add_u32 s20, s18, 21504
    buffer_load_dwordx4 v5, s[36:39], s20 offen lds
    s_cmp_eq_u32 s21, 0
    s_mov_b32 s17, 24
    s_cselect_b32 s17, 20, s17
    s_add_u32 s17, s17, s22
    s_lshl_b32 s17, s17, 11
    s_add_u32 s17, s17, s35
    buffer_load_dwordx4 v[160:163], v3, s[8:11], s17 offen sc0 sc1
    buffer_load_dwordx4 v[164:167], v3, s[8:11], s17 offen offset:1024 sc0 sc1
    buffer_load_dwordx4 v[168:171], v4, s[8:11], s17 offen sc0 sc1
    buffer_load_dwordx4 v[172:175], v4, s[8:11], s17 offen offset:1024 sc0 sc1
    s_waitcnt vmcnt(28)
    ds_read_b64_tr_b16 v[176:177], v8 offset:4096
    ds_read_b64_tr_b16 v[178:179], v8 offset:5120
    ds_read_b64_tr_b16 v[180:181], v9 offset:4096
    ds_read_b64_tr_b16 v[182:183], v9 offset:5120
    ds_read_b64_tr_b16 v[184:185], v8 offset:6144
    ds_read_b64_tr_b16 v[186:187], v8 offset:7168
    ds_read_b64_tr_b16 v[188:189], v9 offset:6144
    ds_read_b64_tr_b16 v[190:191], v9 offset:7168
    s_waitcnt lgkmcnt(4)
    v_mfma_f32_32x32x16_bf16 v[32:47], v[176:179], v[112:115], v[32:47]
    v_mfma_f32_32x32x16_bf16 v[48:63], v[176:179], v[120:123], v[48:63]
    v_mfma_f32_32x32x16_bf16 v[64:79], v[180:183], v[112:115], v[64:79]
    v_mfma_f32_32x32x16_bf16 v[80:95], v[180:183], v[120:123], v[80:95]
    s_waitcnt lgkmcnt(0)
    v_mfma_f32_32x32x16_bf16 v[32:47], v[184:187], v[116:119], v[32:47]
    v_mfma_f32_32x32x16_bf16 v[48:63], v[184:187], v[124:127], v[48:63]
    v_mfma_f32_32x32x16_bf16 v[64:79], v[188:191], v[116:119], v[64:79]
    v_mfma_f32_32x32x16_bf16 v[80:95], v[188:191], v[124:127], v[80:95]
    s_waitcnt vmcnt(16)
    ds_read_b64_tr_b16 v[224:225], v8 offset:20480
    ds_read_b64_tr_b16 v[226:227], v8 offset:21504
    ds_read_b64_tr_b16 v[228:229], v9 offset:20480
    ds_read_b64_tr_b16 v[230:231], v9 offset:21504
    ds_read_b64_tr_b16 v[232:233], v8 offset:22528
    ds_read_b64_tr_b16 v[234:235], v8 offset:23552
    ds_read_b64_tr_b16 v[236:237], v9 offset:22528
    ds_read_b64_tr_b16 v[238:239], v9 offset:23552
    s_waitcnt lgkmcnt(0)
    s_add_u32 s15, s19, 20480
    s_mov_b32 m0, s15
    s_nop 0
    buffer_load_dwordx4 v5, s[40:43], s34 offen lds
    s_add_u32 s15, s19, 21504
    s_mov_b32 m0, s15
    s_add_u32 s20, s34, 7168
    buffer_load_dwordx4 v5, s[40:43], s20 offen lds
    s_add_u32 s15, s19, 22528
    s_mov_b32 m0, s15
    s_add_u32 s20, s34, 14336
    buffer_load_dwordx4 v5, s[40:43], s20 offen lds
    s_add_u32 s15, s19, 23552
    s_mov_b32 m0, s15
    s_add_u32 s20, s34, 21504
    buffer_load_dwordx4 v5, s[40:43], s20 offen lds
    s_add_u32 s34, s34, 25088
    s_cmp_eq_u32 s21, 0
    s_mov_b32 s18, 32
    s_cselect_b32 s18, 28, s18
    s_add_u32 s18, s18, s22
    s_mul_i32 s18, s18, 28672
    s_add_u32 s15, s19, 0
    s_mov_b32 m0, s15
    s_nop 0
    buffer_load_dwordx4 v5, s[36:39], s18 offen lds
    s_add_u32 s15, s19, 1024
    s_mov_b32 m0, s15
    s_add_u32 s20, s18, 7168
    buffer_load_dwordx4 v5, s[36:39], s20 offen lds
    s_add_u32 s15, s19, 2048
    s_mov_b32 m0, s15
    s_add_u32 s20, s18, 14336
    buffer_load_dwordx4 v5, s[36:39], s20 offen lds
    s_add_u32 s15, s19, 3072
    s_mov_b32 m0, s15
    s_add_u32 s20, s18, 21504
    buffer_load_dwordx4 v5, s[36:39], s20 offen lds
    s_cmp_eq_u32 s21, 0
    s_mov_b32 s17, 32
    s_cselect_b32 s17, 28, s17
    s_add_u32 s17, s17, s22
    s_lshl_b32 s17, s17, 11
    s_add_u32 s17, s17, s35
    buffer_load_dwordx4 v[96:99], v3, s[8:11], s17 offen sc0 sc1
    buffer_load_dwordx4 v[100:103], v3, s[8:11], s17 offen offset:1024 sc0 sc1
    buffer_load_dwordx4 v[104:107], v4, s[8:11], s17 offen sc0 sc1
    buffer_load_dwordx4 v[108:111], v4, s[8:11], s17 offen offset:1024 sc0 sc1
    s_waitcnt vmcnt(32)
    ds_read_b64_tr_b16 v[192:193], v8 offset:8192
    ds_read_b64_tr_b16 v[194:195], v8 offset:9216
    ds_read_b64_tr_b16 v[196:197], v9 offset:8192
    ds_read_b64_tr_b16 v[198:199], v9 offset:9216
    ds_read_b64_tr_b16 v[200:201], v8 offset:10240
    ds_read_b64_tr_b16 v[202:203], v8 offset:11264
    ds_read_b64_tr_b16 v[204:205], v9 offset:10240
    ds_read_b64_tr_b16 v[206:207], v9 offset:11264
    s_waitcnt lgkmcnt(4)
    v_mfma_f32_32x32x16_bf16 v[32:47], v[192:195], v[128:131], v[32:47]
    v_mfma_f32_32x32x16_bf16 v[48:63], v[192:195], v[136:139], v[48:63]
    v_mfma_f32_32x32x16_bf16 v[64:79], v[196:199], v[128:131], v[64:79]
    v_mfma_f32_32x32x16_bf16 v[80:95], v[196:199], v[136:139], v[80:95]
    s_waitcnt lgkmcnt(0)
    v_mfma_f32_32x32x16_bf16 v[32:47], v[200:203], v[132:135], v[32:47]
    v_mfma_f32_32x32x16_bf16 v[48:63], v[200:203], v[140:143], v[48:63]
    v_mfma_f32_32x32x16_bf16 v[64:79], v[204:207], v[132:135], v[64:79]
    v_mfma_f32_32x32x16_bf16 v[80:95], v[204:207], v[140:143], v[80:95]
    s_cmp_eq_u32 s21, 0
    s_mov_b32 s18, 40
    s_cselect_b32 s18, 36, s18
    s_add_u32 s18, s18, s22
    s_mul_i32 s18, s18, 28672
    s_add_u32 s15, s19, 4096
    s_mov_b32 m0, s15
    s_nop 0
    buffer_load_dwordx4 v5, s[36:39], s18 offen lds
    s_add_u32 s15, s19, 5120
    s_mov_b32 m0, s15
    s_add_u32 s20, s18, 7168
    buffer_load_dwordx4 v5, s[36:39], s20 offen lds
    s_add_u32 s15, s19, 6144
    s_mov_b32 m0, s15
    s_add_u32 s20, s18, 14336
    buffer_load_dwordx4 v5, s[36:39], s20 offen lds
    s_add_u32 s15, s19, 7168
    s_mov_b32 m0, s15
    s_add_u32 s20, s18, 21504
    buffer_load_dwordx4 v5, s[36:39], s20 offen lds
    s_cmp_eq_u32 s21, 0
    s_mov_b32 s17, 40
    s_cselect_b32 s17, 36, s17
    s_add_u32 s17, s17, s22
    s_lshl_b32 s17, s17, 11
    s_add_u32 s17, s17, s35
    buffer_load_dwordx4 v[112:115], v3, s[8:11], s17 offen sc0 sc1
    buffer_load_dwordx4 v[116:119], v3, s[8:11], s17 offen offset:1024 sc0 sc1
    buffer_load_dwordx4 v[120:123], v4, s[8:11], s17 offen sc0 sc1
    buffer_load_dwordx4 v[124:127], v4, s[8:11], s17 offen offset:1024 sc0 sc1
    s_waitcnt vmcnt(28)
    ds_read_b64_tr_b16 v[176:177], v8 offset:12288
    ds_read_b64_tr_b16 v[178:179], v8 offset:13312
    ds_read_b64_tr_b16 v[180:181], v9 offset:12288
    ds_read_b64_tr_b16 v[182:183], v9 offset:13312
    ds_read_b64_tr_b16 v[184:185], v8 offset:14336
    ds_read_b64_tr_b16 v[186:187], v8 offset:15360
    ds_read_b64_tr_b16 v[188:189], v9 offset:14336
    ds_read_b64_tr_b16 v[190:191], v9 offset:15360
    s_waitcnt lgkmcnt(4)
    v_mfma_f32_32x32x16_bf16 v[32:47], v[176:179], v[144:147], v[32:47]
    v_mfma_f32_32x32x16_bf16 v[48:63], v[176:179], v[152:155], v[48:63]
    v_mfma_f32_32x32x16_bf16 v[64:79], v[180:183], v[144:147], v[64:79]
    v_mfma_f32_32x32x16_bf16 v[80:95], v[180:183], v[152:155], v[80:95]
    s_waitcnt lgkmcnt(0)
    v_mfma_f32_32x32x16_bf16 v[32:47], v[184:187], v[148:151], v[32:47]
    v_mfma_f32_32x32x16_bf16 v[48:63], v[184:187], v[156:159], v[48:63]
    v_mfma_f32_32x32x16_bf16 v[64:79], v[188:191], v[148:151], v[64:79]
    v_mfma_f32_32x32x16_bf16 v[80:95], v[188:191], v[156:159], v[80:95]
    s_waitcnt vmcnt(16)
    ds_read_b64_tr_b16 v[240:241], v8 offset:20480
    ds_read_b64_tr_b16 v[242:243], v8 offset:21504
    ds_read_b64_tr_b16 v[244:245], v9 offset:20480
    ds_read_b64_tr_b16 v[246:247], v9 offset:21504
    ds_read_b64_tr_b16 v[248:249], v8 offset:22528
    ds_read_b64_tr_b16 v[250:251], v8 offset:23552
    ds_read_b64_tr_b16 v[252:253], v9 offset:22528
    ds_read_b64_tr_b16 v[254:255], v9 offset:23552
    s_waitcnt lgkmcnt(0)
    s_add_u32 s15, s19, 20480
    s_mov_b32 m0, s15
    s_nop 0
    buffer_load_dwordx4 v5, s[40:43], s34 offen lds
    s_add_u32 s15, s19, 21504
    s_mov_b32 m0, s15
    s_add_u32 s20, s34, 7168
    buffer_load_dwordx4 v5, s[40:43], s20 offen lds
    s_add_u32 s15, s19, 22528
    s_mov_b32 m0, s15
    s_add_u32 s20, s34, 14336
    buffer_load_dwordx4 v5, s[40:43], s20 offen lds
    s_add_u32 s15, s19, 23552
    s_mov_b32 m0, s15
    s_add_u32 s20, s34, 21504
    buffer_load_dwordx4 v5, s[40:43], s20 offen lds
    s_add_u32 s34, s34, 25088
    s_cmp_eq_u32 s21, 0
    s_mov_b32 s18, 48
    s_cselect_b32 s18, 44, s18
    s_add_u32 s18, s18, s22
    s_mul_i32 s18, s18, 28672
    s_add_u32 s15, s19, 8192
    s_mov_b32 m0, s15
    s_nop 0
    buffer_load_dwordx4 v5, s[36:39], s18 offen lds
    s_add_u32 s15, s19, 9216
    s_mov_b32 m0, s15
    s_add_u32 s20, s18, 7168
    buffer_load_dwordx4 v5, s[36:39], s20 offen lds
    s_add_u32 s15, s19, 10240
    s_mov_b32 m0, s15
    s_add_u32 s20, s18, 14336
    buffer_load_dwordx4 v5, s[36:39], s20 offen lds
    s_add_u32 s15, s19, 11264
    s_mov_b32 m0, s15
    s_add_u32 s20, s18, 21504
    buffer_load_dwordx4 v5, s[36:39], s20 offen lds
    s_cmp_eq_u32 s21, 0
    s_mov_b32 s17, 48
    s_cselect_b32 s17, 44, s17
    s_add_u32 s17, s17, s22
    s_lshl_b32 s17, s17, 11
    s_add_u32 s17, s17, s35
    buffer_load_dwordx4 v[128:131], v3, s[8:11], s17 offen sc0 sc1
    buffer_load_dwordx4 v[132:135], v3, s[8:11], s17 offen offset:1024 sc0 sc1
    buffer_load_dwordx4 v[136:139], v4, s[8:11], s17 offen sc0 sc1
    buffer_load_dwordx4 v[140:143], v4, s[8:11], s17 offen offset:1024 sc0 sc1
    s_waitcnt vmcnt(32)
    ds_read_b64_tr_b16 v[192:193], v8 offset:16384
    ds_read_b64_tr_b16 v[194:195], v8 offset:17408
    ds_read_b64_tr_b16 v[196:197], v9 offset:16384
    ds_read_b64_tr_b16 v[198:199], v9 offset:17408
    ds_read_b64_tr_b16 v[200:201], v8 offset:18432
    ds_read_b64_tr_b16 v[202:203], v8 offset:19456
    ds_read_b64_tr_b16 v[204:205], v9 offset:18432
    ds_read_b64_tr_b16 v[206:207], v9 offset:19456
    s_waitcnt lgkmcnt(4)
    v_mfma_f32_32x32x16_bf16 v[32:47], v[192:195], v[160:163], v[32:47]
    v_mfma_f32_32x32x16_bf16 v[48:63], v[192:195], v[168:171], v[48:63]
    v_mfma_f32_32x32x16_bf16 v[64:79], v[196:199], v[160:163], v[64:79]
    v_mfma_f32_32x32x16_bf16 v[80:95], v[196:199], v[168:171], v[80:95]
    s_waitcnt lgkmcnt(0)
    v_mfma_f32_32x32x16_bf16 v[32:47], v[200:203], v[164:167], v[32:47]
    v_mfma_f32_32x32x16_bf16 v[48:63], v[200:203], v[172:175], v[48:63]
    v_mfma_f32_32x32x16_bf16 v[64:79], v[204:207], v[164:167], v[64:79]
    v_mfma_f32_32x32x16_bf16 v[80:95], v[204:207], v[172:175], v[80:95]
    s_cmp_eq_u32 s21, 0
    s_mov_b32 s18, 54
    s_cselect_b32 s18, 52, s18
    s_add_u32 s18, s18, s22
    s_mul_i32 s18, s18, 28672
    s_add_u32 s15, s19, 12288
    s_mov_b32 m0, s15
    s_nop 0
    buffer_load_dwordx4 v5, s[36:39], s18 offen lds
    s_add_u32 s15, s19, 13312
    s_mov_b32 m0, s15
    s_add_u32 s20, s18, 7168
    buffer_load_dwordx4 v5, s[36:39], s20 offen lds
    s_add_u32 s15, s19, 14336
    s_mov_b32 m0, s15
    s_add_u32 s20, s18, 14336
    buffer_load_dwordx4 v5, s[36:39], s20 offen lds
    s_add_u32 s15, s19, 15360
    s_mov_b32 m0, s15
    s_add_u32 s20, s18, 21504
    buffer_load_dwordx4 v5, s[36:39], s20 offen lds
    s_cmp_eq_u32 s21, 0
    s_mov_b32 s17, 54
    s_cselect_b32 s17, 52, s17
    s_add_u32 s17, s17, s22
    s_lshl_b32 s17, s17, 11
    s_add_u32 s17, s17, s35
    buffer_load_dwordx4 v[144:147], v3, s[8:11], s17 offen sc0 sc1
    buffer_load_dwordx4 v[148:151], v3, s[8:11], s17 offen offset:1024 sc0 sc1
    buffer_load_dwordx4 v[152:155], v4, s[8:11], s17 offen sc0 sc1
    buffer_load_dwordx4 v[156:159], v4, s[8:11], s17 offen offset:1024 sc0 sc1
    s_waitcnt vmcnt(28)
    ds_read_b64_tr_b16 v[176:177], v8 offset:0
    ds_read_b64_tr_b16 v[178:179], v8 offset:1024
    ds_read_b64_tr_b16 v[180:181], v9 offset:0
    ds_read_b64_tr_b16 v[182:183], v9 offset:1024
    ds_read_b64_tr_b16 v[184:185], v8 offset:2048
    ds_read_b64_tr_b16 v[186:187], v8 offset:3072
    ds_read_b64_tr_b16 v[188:189], v9 offset:2048
    ds_read_b64_tr_b16 v[190:191], v9 offset:3072
    s_waitcnt lgkmcnt(4)
    v_mfma_f32_32x32x16_bf16 v[32:47], v[176:179], v[96:99], v[32:47]
    v_mfma_f32_32x32x16_bf16 v[48:63], v[176:179], v[104:107], v[48:63]
    v_mfma_f32_32x32x16_bf16 v[64:79], v[180:183], v[96:99], v[64:79]
    v_mfma_f32_32x32x16_bf16 v[80:95], v[180:183], v[104:107], v[80:95]
    s_waitcnt lgkmcnt(0)
    v_mfma_f32_32x32x16_bf16 v[32:47], v[184:187], v[100:103], v[32:47]
    v_mfma_f32_32x32x16_bf16 v[48:63], v[184:187], v[108:111], v[48:63]
    v_mfma_f32_32x32x16_bf16 v[64:79], v[188:191], v[100:103], v[64:79]
    v_mfma_f32_32x32x16_bf16 v[80:95], v[188:191], v[108:111], v[80:95]
    s_add_u32 s15, s19, 16384
    s_mov_b32 m0, s15
    s_nop 0
    buffer_load_dwordx4 v5, s[40:43], s34 offen lds
    s_add_u32 s15, s19, 17408
    s_mov_b32 m0, s15
    s_add_u32 s20, s34, 7168
    buffer_load_dwordx4 v5, s[40:43], s20 offen lds
    s_add_u32 s15, s19, 18432
    s_mov_b32 m0, s15
    s_add_u32 s20, s34, 14336
    buffer_load_dwordx4 v5, s[40:43], s20 offen lds
    s_add_u32 s15, s19, 19456
    s_mov_b32 m0, s15
    s_add_u32 s20, s34, 21504
    buffer_load_dwordx4 v5, s[40:43], s20 offen lds
    s_add_u32 s34, s34, 25088
    s_waitcnt vmcnt(24)
    ds_read_b64_tr_b16 v[192:193], v8 offset:4096
    ds_read_b64_tr_b16 v[194:195], v8 offset:5120
    ds_read_b64_tr_b16 v[196:197], v9 offset:4096
    ds_read_b64_tr_b16 v[198:199], v9 offset:5120
    ds_read_b64_tr_b16 v[200:201], v8 offset:6144
    ds_read_b64_tr_b16 v[202:203], v8 offset:7168
    ds_read_b64_tr_b16 v[204:205], v9 offset:6144
    ds_read_b64_tr_b16 v[206:207], v9 offset:7168
    s_waitcnt lgkmcnt(4)
    v_mfma_f32_32x32x16_bf16 v[32:47], v[192:195], v[112:115], v[32:47]
    v_mfma_f32_32x32x16_bf16 v[48:63], v[192:195], v[120:123], v[48:63]
    v_mfma_f32_32x32x16_bf16 v[64:79], v[196:199], v[112:115], v[64:79]
    v_mfma_f32_32x32x16_bf16 v[80:95], v[196:199], v[120:123], v[80:95]
    s_waitcnt lgkmcnt(0)
    v_mfma_f32_32x32x16_bf16 v[32:47], v[200:203], v[116:119], v[32:47]
    v_mfma_f32_32x32x16_bf16 v[48:63], v[200:203], v[124:127], v[48:63]
    v_mfma_f32_32x32x16_bf16 v[64:79], v[204:207], v[116:119], v[64:79]
    v_mfma_f32_32x32x16_bf16 v[80:95], v[204:207], v[124:127], v[80:95]
    s_add_u32 s15, s19, 0
    s_mov_b32 m0, s15
    s_nop 0
    buffer_load_dwordx4 v5, s[40:43], s34 offen lds
    s_add_u32 s15, s19, 1024
    s_mov_b32 m0, s15
    s_add_u32 s20, s34, 7168
    buffer_load_dwordx4 v5, s[40:43], s20 offen lds
    s_add_u32 s15, s19, 2048
    s_mov_b32 m0, s15
    s_add_u32 s20, s34, 14336
    buffer_load_dwordx4 v5, s[40:43], s20 offen lds
    s_add_u32 s15, s19, 3072
    s_mov_b32 m0, s15
    s_add_u32 s20, s34, 21504
    buffer_load_dwordx4 v5, s[40:43], s20 offen lds
    s_add_u32 s34, s34, 25088
    s_waitcnt vmcnt(16)
    ds_read_b64_tr_b16 v[176:177], v8 offset:8192
    ds_read_b64_tr_b16 v[178:179], v8 offset:9216
    ds_read_b64_tr_b16 v[180:181], v9 offset:8192
    ds_read_b64_tr_b16 v[182:183], v9 offset:9216
    ds_read_b64_tr_b16 v[184:185], v8 offset:10240
    ds_read_b64_tr_b16 v[186:187], v8 offset:11264
    ds_read_b64_tr_b16 v[188:189], v9 offset:10240
    ds_read_b64_tr_b16 v[190:191], v9 offset:11264
    s_waitcnt lgkmcnt(4)
    v_mfma_f32_32x32x16_bf16 v[32:47], v[176:179], v[128:131], v[32:47]
    v_mfma_f32_32x32x16_bf16 v[48:63], v[176:179], v[136:139], v[48:63]
    v_mfma_f32_32x32x16_bf16 v[64:79], v[180:183], v[128:131], v[64:79]
    v_mfma_f32_32x32x16_bf16 v[80:95], v[180:183], v[136:139], v[80:95]
    s_waitcnt lgkmcnt(0)
    v_mfma_f32_32x32x16_bf16 v[32:47], v[184:187], v[132:135], v[32:47]
    v_mfma_f32_32x32x16_bf16 v[48:63], v[184:187], v[140:143], v[48:63]
    v_mfma_f32_32x32x16_bf16 v[64:79], v[188:191], v[132:135], v[64:79]
    v_mfma_f32_32x32x16_bf16 v[80:95], v[188:191], v[140:143], v[80:95]
    s_waitcnt vmcnt(8)
    ds_read_b64_tr_b16 v[192:193], v8 offset:12288
    ds_read_b64_tr_b16 v[194:195], v8 offset:13312
    ds_read_b64_tr_b16 v[196:197], v9 offset:12288
    ds_read_b64_tr_b16 v[198:199], v9 offset:13312
    ds_read_b64_tr_b16 v[200:201], v8 offset:14336
    ds_read_b64_tr_b16 v[202:203], v8 offset:15360
    ds_read_b64_tr_b16 v[204:205], v9 offset:14336
    ds_read_b64_tr_b16 v[206:207], v9 offset:15360
    s_waitcnt lgkmcnt(4)
    v_mfma_f32_32x32x16_bf16 v[32:47], v[192:195], v[144:147], v[32:47]
    v_mfma_f32_32x32x16_bf16 v[48:63], v[192:195], v[152:155], v[48:63]
    v_mfma_f32_32x32x16_bf16 v[64:79], v[196:199], v[144:147], v[64:79]
    v_mfma_f32_32x32x16_bf16 v[80:95], v[196:199], v[152:155], v[80:95]
    s_waitcnt lgkmcnt(0)
    v_mfma_f32_32x32x16_bf16 v[32:47], v[200:203], v[148:151], v[32:47]
    v_mfma_f32_32x32x16_bf16 v[48:63], v[200:203], v[156:159], v[48:63]
    v_mfma_f32_32x32x16_bf16 v[64:79], v[204:207], v[148:151], v[64:79]
    v_mfma_f32_32x32x16_bf16 v[80:95], v[204:207], v[156:159], v[80:95]
    s_setprio 2
    buffer_load_dwordx2 v[176:177], v11, s[48:51], 0 offen offset:0
    buffer_load_dwordx2 v[178:179], v11, s[48:51], 0 offen offset:16
    buffer_load_dwordx2 v[180:181], v11, s[48:51], 0 offen offset:32
    buffer_load_dwordx2 v[182:183], v11, s[48:51], 0 offen offset:48
    s_lshl_b32 s15, s12, 2
    v_add_u32 v28, s15, v22
    s_waitcnt lgkmcnt(0)
    ds_write_b32 v28, v13 offset:16
    s_mov_b32 s62, 0
    s_setprio 0
    s_branch LW4_1
LW4:
    s_sleep 1
LW4_1:
    s_add_u32 s62, s62, 1
    s_cmp_gt_u32 s62, 0x40000
    s_cbranch_scc1 LW4_X
    ds_read_b128 v[24:27], v22 offset:16
    s_waitcnt lgkmcnt(0)
    v_and_b32 v24, v24, v25
    v_and_b32 v26, v26, v27
    v_and_b32 v24, v24, v26
    s_nop 0
    v_readfirstlane_b32 s15, v24
    s_nop 0
    s_cmp_eq_u32 s15, 1
    s_cbranch_scc0 LW4
LW4_X:
    s_setprio 2
    s_xor_b32 s15, s12, 1
    s_mul_i32 s15, s15, 24576
    s_add_u32 s15, s15, 55296
    v_add_u32 v6, s15, v2
    ds_write_b128 v6, v[48:51] offset:0
    ds_write_b128 v6, v[52:55] offset:1024
    ds_write_b128 v6, v[56:59] offset:2048
    ds_write_b128 v6, v[60:63] offset:3072
    s_xor_b32 s15, s12, 2
    s_mul_i32 s15, s15, 24576
    s_add_u32 s15, s15, 59392
    v_add_u32 v6, s15, v2
    ds_write_b128 v6, v[64:67] offset:0
    ds_write_b128 v6, v[68:71] offset:1024
    ds_write_b128 v6, v[72:75] offset:2048
    ds_write_b128 v6, v[76:79] offset:3072
    s_xor_b32 s15, s12, 3
    s_mul_i32 s15, s15, 24576
    s_add_u32 s15, s15, 63488
    v_add_u32 v6, s15, v2
    ds_write_b128 v6, v[80:83] offset:0
    ds_write_b128 v6, v[84:87] offset:1024
    ds_write_b128 v6, v[88:91] offset:2048
    ds_write_b128 v6, v[92:95] offset:3072
    s_waitcnt lgkmcnt(0)
    ds_write_b32 v28, v13 offset:32
    s_waitcnt vmcnt(28)
    ds_read_b64_tr_b16 v[96:97], v8 offset:20480
    ds_read_b64_tr_b16 v[98:99], v8 offset:21504
    ds_read_b64_tr_b16 v[100:101], v9 offset:20480
    ds_read_b64_tr_b16 v[102:103], v9 offset:21504
    ds_read_b64_tr_b16 v[104:105], v8 offset:22528
    ds_read_b64_tr_b16 v[106:107], v8 offset:23552
    ds_read_b64_tr_b16 v[108:109], v9 offset:22528
    ds_read_b64_tr_b16 v[110:111], v9 offset:23552
    s_waitcnt vmcnt(8)
    ds_read_b64_tr_b16 v[112:113], v8 offset:16384
    ds_read_b64_tr_b16 v[114:115], v8 offset:17408
    ds_read_b64_tr_b16 v[116:117], v9 offset:16384
    ds_read_b64_tr_b16 v[118:119], v9 offset:17408
    ds_read_b64_tr_b16 v[120:121], v8 offset:18432
    ds_read_b64_tr_b16 v[122:123], v8 offset:19456
    ds_read_b64_tr_b16 v[124:125], v9 offset:18432
    ds_read_b64_tr_b16 v[126:127], v9 offset:19456
    s_waitcnt vmcnt(4)
    ds_read_b64_tr_b16 v[128:129], v8 offset:0
    ds_read_b64_tr_b16 v[130:131], v8 offset:1024
    ds_read_b64_tr_b16 v[132:133], v9 offset:0
    ds_read_b64_tr_b16 v[134:135], v9 offset:1024
    ds_read_b64_tr_b16 v[136:137], v8 offset:2048
    ds_read_b64_tr_b16 v[138:139], v8 offset:3072
    ds_read_b64_tr_b16 v[140:141], v9 offset:2048
    ds_read_b64_tr_b16 v[142:143], v9 offset:3072
    s_waitcnt vmcnt(0)
    s_mov_b32 s60, 0xffff0000
    v_lshlrev_b32 v192, 16, v14
    v_and_b32 v193, s60, v14
    v_lshlrev_b32 v194, 16, v176
    v_and_b32 v195, s60, v176
    v_add_f32 v32, v32, v192
    v_add_f32 v33, v33, v193
    v_add_f32 v32, v32, v194
    v_add_f32 v33, v33, v195
    v_lshlrev_b32 v196, 16, v15
    v_and_b32 v197, s60, v15
    v_lshlrev_b32 v198, 16, v177
    v_and_b32 v199, s60, v177
    v_add_f32 v34, v34, v196
    v_add_f32 v35, v35, v197
    v_add_f32 v34, v34, v198
    v_add_f32 v35, v35, v199
    v_lshlrev_b32 v192, 16, v16
    v_and_b32 v193, s60, v16
    v_lshlrev_b32 v194, 16, v178
    v_and_b32 v195, s60, v178
    v_add_f32 v36, v36, v192
    v_add_f32 v37, v37, v193
    v_add_f32 v36, v36, v194
    v_add_f32 v37, v37, v195
    v_lshlrev_b32 v196, 16, v17
    v_and_b32 v197, s60, v17
    v_lshlrev_b32 v198, 16, v179
    v_and_b32 v199, s60, v179
    v_add_f32 v38, v38, v196
    v_add_f32 v39, v39, v197
    v_add_f32 v38, v38, v198
    v_add_f32 v39, v39, v199
    v_lshlrev_b32 v192, 16, v18
    v_and_b32 v193, s60, v18
    v_lshlrev_b32 v194, 16, v180
    v_and_b32 v195, s60, v180
    v_add_f32 v40, v40, v192
    v_add_f32 v41, v41, v193
    v_add_f32 v40, v40, v194
    v_add_f32 v41, v41, v195
    v_lshlrev_b32 v196, 16, v19
    v_and_b32 v197, s60, v19
    v_lshlrev_b32 v198, 16, v181
    v_and_b32 v199, s60, v181
    v_add_f32 v42, v42, v196
    v_add_f32 v43, v43, v197
    v_add_f32 v42, v42, v198
    v_add_f32 v43, v43, v199
    v_lshlrev_b32 v192, 16, v20
    v_and_b32 v193, s60, v20
    v_lshlrev_b32 v194, 16, v182
    v_and_b32 v195, s60, v182
    v_add_f32 v44, v44, v192
    v_add_f32 v45, v45, v193
    v_add_f32 v44, v44, v194
    v_add_f32 v45, v45, v195
    v_lshlrev_b32 v196, 16, v21
    v_and_b32 v197, s60, v21
    v_lshlrev_b32 v198, 16, v183
    v_and_b32 v199, s60, v183
    v_add_f32 v46, v46, v196
    v_add_f32 v47, v47, v197
    v_add_f32 v46, v46, v198
    v_add_f32 v47, v47, v199
    s_mov_b32 s62, 0
    s_setprio 0
    s_branch LW5_1
LW5:
    s_sleep 1
LW5_1:
    s_add_u32 s62, s62, 1
    s_cmp_gt_u32 s62, 0x40000
    s_cbranch_scc1 LW5_X
    ds_read_b128 v[24:27], v22 offset:32
    s_waitcnt lgkmcnt(0)
    v_and_b32 v24, v24, v25
    v_and_b32 v26, v26, v27
    v_and_b32 v24, v24, v26
    s_nop 0
    v_readfirstlane_b32 s15, v24
    s_nop 0
    s_cmp_eq_u32 s15, 1
    s_cbranch_scc0 LW5
LW5_X:
    s_setprio 2
    v_add_u32 v6, s19, v2
    ds_read_b128 v[48:51], v6 offset:4096
    ds_read_b128 v[52:55], v6 offset:5120
    ds_read_b128 v[56:59], v6 offset:6144
    ds_read_b128 v[60:63], v6 offset:7168
    ds_read_b128 v[64:67], v6 offset:8192
    ds_read_b128 v[68:71], v6 offset:9216
    ds_read_b128 v[72:75], v6 offset:10240
    ds_read_b128 v[76:79], v6 offset:11264
    ds_read_b128 v[80:83], v6 offset:12288
    ds_read_b128 v[84:87], v6 offset:13312
    ds_read_b128 v[88:91], v6 offset:14336
    ds_read_b128 v[92:95], v6 offset:15360
    s_waitcnt lgkmcnt(8)
    v_add_f32 v32, v32, v48
    v_add_f32 v33, v33, v49
    v_add_f32 v34, v34, v50
    v_add_f32 v35, v35, v51
    v_add_f32 v36, v36, v52
    v_add_f32 v37, v37, v53
    v_add_f32 v38, v38, v54
    v_add_f32 v39, v39, v55
    v_add_f32 v40, v40, v56
    v_add_f32 v41, v41, v57
    v_add_f32 v42, v42, v58
    v_add_f32 v43, v43, v59
    v_add_f32 v44, v44, v60
    v_add_f32 v45, v45, v61
    v_add_f32 v46, v46, v62
    v_add_f32 v47, v47, v63
    s_waitcnt lgkmcnt(4)
    v_add_f32 v32, v32, v64
    v_add_f32 v33, v33, v65
    v_add_f32 v34, v34, v66
    v_add_f32 v35, v35, v67
    v_add_f32 v36, v36, v68
    v_add_f32 v37, v37, v69
    v_add_f32 v38, v38, v70
    v_add_f32 v39, v39, v71
    v_add_f32 v40, v40, v72
    v_add_f32 v41, v41, v73
    v_add_f32 v42, v42, v74
    v_add_f32 v43, v43, v75
    v_add_f32 v44, v44, v76
    v_add_f32 v45, v45, v77
    v_add_f32 v46, v46, v78
    v_add_f32 v47, v47, v79
    s_waitcnt lgkmcnt(0)
    v_add_f32 v32, v32, v80
    v_add_f32 v33, v33, v81
    v_add_f32 v34, v34, v82
    v_add_f32 v35, v35, v83
    v_add_f32 v36, v36, v84
    v_add_f32 v37, v37, v85
    v_add_f32 v38, v38, v86
    v_add_f32 v39, v39, v87
    v_add_f32 v40, v40, v88
    v_add_f32 v41, v41, v89
    v_add_f32 v42, v42, v90
    v_add_f32 v43, v43, v91
    v_add_f32 v44, v44, v92
    v_add_f32 v45, v45, v93
    v_add_f32 v46, v46, v94
    v_add_f32 v47, v47, v95
    s_add_u32 s15, s19, 4096
    s_mov_b32 m0, s15
    s_nop 0
    buffer_load_dwordx4 v5, s[40:43], s34 offen lds
    s_add_u32 s15, s19, 5120
    s_mov_b32 m0, s15
    s_add_u32 s20, s34, 7168
    buffer_load_dwordx4 v5, s[40:43], s20 offen lds
    s_add_u32 s15, s19, 6144
    s_mov_b32 m0, s15
    s_add_u32 s20, s34, 14336
    buffer_load_dwordx4 v5, s[40:43], s20 offen lds
    s_add_u32 s15, s19, 7168
    s_mov_b32 m0, s15
    s_add_u32 s20, s34, 21504
    buffer_load_dwordx4 v5, s[40:43], s20 offen lds
    s_add_u32 s34, s34, 25088
    s_add_u32 s15, s19, 8192
    s_mov_b32 m0, s15
    s_nop 0
    buffer_load_dwordx4 v5, s[40:43], s34 offen lds
    s_add_u32 s15, s19, 9216
    s_mov_b32 m0, s15
    s_add_u32 s20, s34, 7168
    buffer_load_dwordx4 v5, s[40:43], s20 offen lds
    s_add_u32 s15, s19, 10240
    s_mov_b32 m0, s15
    s_add_u32 s20, s34, 14336
    buffer_load_dwordx4 v5, s[40:43], s20 offen lds
    s_add_u32 s15, s19, 11264
    s_mov_b32 m0, s15
    s_add_u32 s20, s34, 21504
    buffer_load_dwordx4 v5, s[40:43], s20 offen lds
    s_add_u32 s34, s34, 25088
    s_lshl_b32 s15, s13, 1
    s_add_u32 s15, s15, s22
    s_lshl_b32 s23, s15, 4
    s_lshl_b32 s16, s21, 3
    s_add_u32 s23, s23, s16
    v_and_b32 v6, 7, v1
    v_add_u32 v6, s23, v6
    v_lshlrev_b32 v29, 7, v6
    s_mul_i32 s17, s15, 147456
    s_lshl_b32 s16, s21, 14
    s_add_u32 s17, s17, s16
    s_add_u32 s17, s17, 6406144
    s_waitcnt vmcnt(0)
    ds_read_b64_tr_b16 v[144:145], v8 offset:4096
    ds_read_b64_tr_b16 v[146:147], v8 offset:5120
    ds_read_b64_tr_b16 v[148:149], v9 offset:4096
    ds_read_b64_tr_b16 v[150:151], v9 offset:5120
    ds_read_b64_tr_b16 v[152:153], v8 offset:6144
    ds_read_b64_tr_b16 v[154:155], v8 offset:7168
    ds_read_b64_tr_b16 v[156:157], v9 offset:6144
    ds_read_b64_tr_b16 v[158:159], v9 offset:7168
    ds_read_b64_tr_b16 v[160:161], v8 offset:8192
    ds_read_b64_tr_b16 v[162:163], v8 offset:9216
    ds_read_b64_tr_b16 v[164:165], v9 offset:8192
    ds_read_b64_tr_b16 v[166:167], v9 offset:9216
    ds_read_b64_tr_b16 v[168:169], v8 offset:10240
    ds_read_b64_tr_b16 v[170:171], v8 offset:11264
    ds_read_b64_tr_b16 v[172:173], v9 offset:10240
    ds_read_b64_tr_b16 v[174:175], v9 offset:11264
    s_waitcnt lgkmcnt(0)
    ds_write_b32 v28, v13 offset:64
    s_setprio 0
    s_mov_b32 s61, 0
    s_mov_b32 s63, 20054016
    s_branch GP_GO_1
GP_GO:
    s_sleep 1
GP_GO_1:
    buffer_load_dword v7, v29, s[8:11], s63 offen sc0 sc1
    s_waitcnt vmcnt(0)
    v_cmp_ne_u32 vcc, s94, v7
    s_add_u32 s61, s61, 1
    s_cmp_gt_u32 s61, 0x20000
    s_cbranch_scc1 GP_GO_X
    s_cbranch_vccnz GP_GO
GP_GO_X:
    s_setprio 2
    s_add_u32 s15, s17, 0
    buffer_load_dwordx4 v[64:67], v2, s[8:11], s15 offen sc0 sc1
    buffer_load_dwordx4 v[68:71], v2, s[8:11], s15 offen offset:1024 sc0 sc1
    s_add_u32 s15, s17, 2048
    buffer_load_dwordx4 v[72:75], v2, s[8:11], s15 offen sc0 sc1
    buffer_load_dwordx4 v[76:79], v2, s[8:11], s15 offen offset:1024 sc0 sc1
    s_add_u32 s15, s17, 4096
    buffer_load_dwordx4 v[80:83], v2, s[8:11], s15 offen sc0 sc1
    buffer_load_dwordx4 v[84:87], v2, s[8:11], s15 offen offset:1024 sc0 sc1
    s_add_u32 s15, s17, 6144
    buffer_load_dwordx4 v[88:91], v2, s[8:11], s15 offen sc0 sc1
    buffer_load_dwordx4 v[92:95], v2, s[8:11], s15 offen offset:1024 sc0 sc1
    s_add_u32 s15, s17, 8192
    buffer_load_dwordx4 v[176:179], v2, s[8:11], s15 offen sc0 sc1
    buffer_load_dwordx4 v[180:183], v2, s[8:11], s15 offen offset:1024 sc0 sc1
    s_add_u32 s15, s17, 10240
    buffer_load_dwordx4 v[184:187], v2, s[8:11], s15 offen sc0 sc1
    buffer_load_dwordx4 v[188:191], v2, s[8:11], s15 offen offset:1024 sc0 sc1
    s_add_u32 s15, s17, 12288
    buffer_load_dwordx4 v[192:195], v2, s[8:11], s15 offen sc0 sc1
    buffer_load_dwordx4 v[196:199], v2, s[8:11], s15 offen offset:1024 sc0 sc1
    s_add_u32 s15, s17, 14336
    buffer_load_dwordx4 v[200:203], v2, s[8:11], s15 offen sc0 sc1
    buffer_load_dwordx4 v[204:207], v2, s[8:11], s15 offen offset:1024 sc0 sc1
    s_waitcnt vmcnt(14)
    v_mfma_f32_32x32x16_bf16 v[32:47], v[208:211], v[64:67], v[32:47]
    v_mfma_f32_32x32x16_bf16 v[48:63], v[212:215], v[64:67], 0
    v_mfma_f32_32x32x16_bf16 v[32:47], v[216:219], v[68:71], v[32:47]
    v_mfma_f32_32x32x16_bf16 v[48:63], v[220:223], v[68:71], v[48:63]
    s_waitcnt vmcnt(12)
    v_mfma_f32_32x32x16_bf16 v[32:47], v[224:227], v[72:75], v[32:47]
    v_mfma_f32_32x32x16_bf16 v[48:63], v[228:231], v[72:75], v[48:63]
    v_mfma_f32_32x32x16_bf16 v[32:47], v[232:235], v[76:79], v[32:47]
    v_mfma_f32_32x32x16_bf16 v[48:63], v[236:239], v[76:79], v[48:63]
    s_waitcnt vmcnt(10)
    v_mfma_f32_32x32x16_bf16 v[32:47], v[240:243], v[80:83], v[32:47]
    v_mfma_f32_32x32x16_bf16 v[48:63], v[244:247], v[80:83], v[48:63]
    v_mfma_f32_32x32x16_bf16 v[32:47], v[248:251], v[84:87], v[32:47]
    v_mfma_f32_32x32x16_bf16 v[48:63], v[252:255], v[84:87], v[48:63]
    s_waitcnt vmcnt(8)
    v_mfma_f32_32x32x16_bf16 v[32:47], v[96:99], v[88:91], v[32:47]
    v_mfma_f32_32x32x16_bf16 v[48:63], v[100:103], v[88:91], v[48:63]
    v_mfma_f32_32x32x16_bf16 v[32:47], v[104:107], v[92:95], v[32:47]
    v_mfma_f32_32x32x16_bf16 v[48:63], v[108:111], v[92:95], v[48:63]
    s_waitcnt vmcnt(6)
    v_mfma_f32_32x32x16_bf16 v[32:47], v[112:115], v[176:179], v[32:47]
    v_mfma_f32_32x32x16_bf16 v[48:63], v[116:119], v[176:179], v[48:63]
    v_mfma_f32_32x32x16_bf16 v[32:47], v[120:123], v[180:183], v[32:47]
    v_mfma_f32_32x32x16_bf16 v[48:63], v[124:127], v[180:183], v[48:63]
    s_waitcnt vmcnt(4)
    v_mfma_f32_32x32x16_bf16 v[32:47], v[128:131], v[184:187], v[32:47]
    v_mfma_f32_32x32x16_bf16 v[48:63], v[132:135], v[184:187], v[48:63]
    v_mfma_f32_32x32x16_bf16 v[32:47], v[136:139], v[188:191], v[32:47]
    v_mfma_f32_32x32x16_bf16 v[48:63], v[140:143], v[188:191], v[48:63]
    s_waitcnt vmcnt(2)
    v_mfma_f32_32x32x16_bf16 v[32:47], v[144:147], v[192:195], v[32:47]
    v_mfma_f32_32x32x16_bf16 v[48:63], v[148:151], v[192:195], v[48:63]
    v_mfma_f32_32x32x16_bf16 v[32:47], v[152:155], v[196:199], v[32:47]
    v_mfma_f32_32x32x16_bf16 v[48:63], v[156:159], v[196:199], v[48:63]
    s_waitcnt vmcnt(0)
    v_mfma_f32_32x32x16_bf16 v[32:47], v[160:163], v[200:203], v[32:47]
    v_mfma_f32_32x32x16_bf16 v[48:63], v[164:167], v[200:203], v[48:63]
    v_mfma_f32_32x32x16_bf16 v[32:47], v[168:171], v[204:207], v[32:47]
    v_mfma_f32_32x32x16_bf16 v[48:63], v[172:175], v[204:207], v[48:63]
    s_mov_b32 s62, 0
    s_setprio 0
    s_branch LW6_1
LW6:
    s_sleep 1
LW6_1:
    s_add_u32 s62, s62, 1
    s_cmp_gt_u32 s62, 0x40000
    s_cbranch_scc1 LW6_X
    ds_read_b128 v[24:27], v22 offset:64
    s_waitcnt lgkmcnt(0)
    v_and_b32 v24, v24, v25
    v_and_b32 v26, v26, v27
    v_and_b32 v24, v24, v26
    s_nop 0
    v_readfirstlane_b32 s15, v24
    s_nop 0
    s_cmp_eq_u32 s15, 1
    s_cbranch_scc0 LW6
LW6_X:
    s_setprio 2
    s_xor_b32 s15, s12, 2
    s_mul_i32 s15, s15, 24576
    s_add_u32 s15, s15, 63488
    v_add_u32 v6, s15, v2
    s_nop 0
    ds_write_b128 v6, v[48:51] offset:0
    ds_write_b128 v6, v[52:55] offset:1024
    ds_write_b128 v6, v[56:59] offset:2048
    ds_write_b128 v6, v[60:63] offset:3072
    s_waitcnt lgkmcnt(0)
    ds_write_b32 v28, v13 offset:48
    s_mov_b32 s62, 0
    s_setprio 0
    s_branch LW7_1
LW7:
    s_sleep 1
LW7_1:
    s_add_u32 s62, s62, 1
    s_cmp_gt_u32 s62, 0x40000
    s_cbranch_scc1 LW7_X
    ds_read_b128 v[24:27], v22 offset:48
    s_waitcnt lgkmcnt(0)
    v_and_b32 v24, v24, v25
    v_and_b32 v26, v26, v27
    v_and_b32 v24, v24, v26
    s_nop 0
    v_readfirstlane_b32 s15, v24
    s_nop 0
    s_cmp_eq_u32 s15, 1
    s_cbranch_scc0 LW7
LW7_X:
    s_setprio 2
    v_add_u32 v6, s19, v2
    ds_read_b128 v[64:67], v6 offset:12288
    ds_read_b128 v[68:71], v6 offset:13312
    ds_read_b128 v[72:75], v6 offset:14336
    ds_read_b128 v[76:79], v6 offset:15360
    s_waitcnt lgkmcnt(0)
    v_add_f32 v32, v32, v64
    v_add_f32 v33, v33, v65
    v_add_f32 v34, v34, v66
    v_add_f32 v35, v35, v67
    v_add_f32 v36, v36, v68
    v_add_f32 v37, v37, v69
    v_add_f32 v38, v38, v70
    v_add_f32 v39, v39, v71
    v_add_f32 v40, v40, v72
    v_add_f32 v41, v41, v73
    v_add_f32 v42, v42, v74
    v_add_f32 v43, v43, v75
    v_add_f32 v44, v44, v76
    v_add_f32 v45, v45, v77
    v_add_f32 v46, v46, v78
    v_add_f32 v47, v47, v79
    v_cvt_pk_bf16_f32 v80, v32, v33
    v_cvt_pk_bf16_f32 v81, v34, v35
    v_cvt_pk_bf16_f32 v82, v36, v37
    v_cvt_pk_bf16_f32 v83, v38, v39
    v_cvt_pk_bf16_f32 v84, v40, v41
    v_cvt_pk_bf16_f32 v85, v42, v43
    v_cvt_pk_bf16_f32 v86, v44, v45
    v_cvt_pk_bf16_f32 v87, v46, v47
    v_permlane32_swap_b32 v80, v82
    v_permlane32_swap_b32 v81, v83
    v_permlane32_swap_b32 v84, v86
    v_permlane32_swap_b32 v85, v87
    v_lshrrev_b32 v6, 5, v1
    v_lshl_add_u32 v6, v6, 3, v10
    buffer_store_dwordx4 v[80:83], v6, s[52:55], 0 offen offset:0
    buffer_store_dwordx4 v[84:87], v6, s[52:55], 0 offen offset:32
    s_endpgm
MG_IDLE:
    s_waitcnt vmcnt(0)
    v_mov_b32 v3, 157828
    v_mov_b32 v4, 1
    s_mov_b64 exec, 1
    ds_add_rtn_u32 v5, v3, v4
    s_waitcnt lgkmcnt(0)
    v_readfirstlane_b32 s95, v5
    s_nop 3
    s_cmp_lg_u32 s95, 3
    s_cbranch_scc1 PUB_M2
    s_lshl_b32 s95, s13, 4
    s_add_u32 s95, s95, s14
    s_lshl_b32 s95, s95, 7
    s_add_u32 s95, s95, 19955712
    v_mov_b32 v4, s94
    v_mov_b32 v3, 0
    buffer_store_dword v4, v3, s[8:11], s95 offen sc0 sc1
PUB_M2:
    s_mov_b64 exec, -1
MG_EXIT:
    s_endpgm
CODE_END:
.section .rodata,"a"
.p2align 6
.amdhsa_kernel fused_kernel
  .amdhsa_next_free_vgpr 256
  .amdhsa_next_free_sgpr 102
  .amdhsa_accum_offset 256
  .amdhsa_group_segment_fixed_size 0
  .amdhsa_kernarg_size 88
  .amdhsa_user_sgpr_count 2
  .amdhsa_user_sgpr_kernarg_segment_ptr 1
  .amdhsa_system_sgpr_workgroup_id_x 1
.end_amdhsa_kernel
```
